```python
import torch

def _softmax(x, axis=-1):
    return torch.softmax(x, dim=axis)
def _gelu(x):
    return torch.nn.functional.gelu(x, approximate="tanh")
def _silu(x):
    return torch.nn.functional.silu(x)
def _sigmoid(x):
    return torch.sigmoid(x)
def _layernorm(x, axis=-1, eps=1e-5):
    m = x.mean(dim=axis, keepdim=True)
    v = x.var(dim=axis, keepdim=True, unbiased=False)
    return (x - m) / torch.sqrt(v + eps)
def _scatter_add(tgt, idx, src, axis=0):
    return tgt.clone().index_add_(axis, idx, src)
def _segment_sum(src, seg, n):
    out = torch.zeros((n,) + src.shape[1:], dtype=src.dtype)
    return out.index_add_(0, seg, src)
def _pad(x, pw):
    flat = tuple(v for pair in reversed(pw) for v in pair)
    return torch.nn.functional.pad(x, flat)

kernel_name = 'gated_mix__gqa_block_cached__dense_activation_squared_relu__decode'

def setup_inputs():

    _w = (lambda a: (lambda t: t.to(torch.bfloat16) if t.is_floating_point() else t)(torch.as_tensor(a)))
    def _A_setup():
        B, Sq, D = 8, 1, 512
        Hq, Hkv, Sk, Dh = 32, 8, 4096, 128
        assert Hq % Hkv == 0, (Hq, Hkv)
        return {
            "x": _w((lambda *s: torch.randn(*s, dtype=torch.bfloat16) * 0.05)(B, Sq, D)),
            "k_cache": _w((lambda *s: torch.randn(*s, dtype=torch.bfloat16) * 6.4)(B, Hkv, Sk, Dh)),
            "v_cache": _w((lambda *s: torch.randn(*s, dtype=torch.bfloat16) * 0.4)(B, Hkv, Sk, Dh)),
            "wq": _w((lambda *s: torch.randn(*s, dtype=torch.bfloat16) * 6.4)(D, Hq * Dh) * (D ** -0.5)),
            "wo": _w((lambda *s: torch.randn(*s, dtype=torch.bfloat16) * 0.4)(Hq * Dh, D) * ((Hq * Dh) ** -0.5)),
        }
    _A_in = _A_setup()

    def _B_setup():
        B, S, D, F = 8, 1, 512, 1792
        return {
            "x": _w((lambda *s: torch.randn(*s, dtype=torch.bfloat16) * 0.05)(B, S, D)),
            "w1": _w((lambda *s: torch.randn(*s, dtype=torch.bfloat16) * 0.05)(D, F)),
            "b1": _w((lambda *s: torch.randn(*s, dtype=torch.bfloat16) * 0.05)(F)),
            "w2": _w((lambda *s: torch.randn(*s, dtype=torch.bfloat16) * 0.05)(F, D)),
            "b2": _w((lambda *s: torch.randn(*s, dtype=torch.bfloat16) * 0.05)(D)),
        }
    _B_in = _B_setup()

    return {
        "A_x": _A_in["x"],
        "A_k_cache": _A_in["k_cache"],
        "A_v_cache": _A_in["v_cache"],
        "A_wq": _A_in["wq"],
        "A_wo": _A_in["wo"],
        "B_x": _B_in["x"],
        "B_w1": _B_in["w1"],
        "B_b1": _B_in["b1"],
        "B_w2": _B_in["w2"],
        "B_b2": _B_in["b2"],
        "gate_w": _w((lambda *s: torch.randn(*s, dtype=torch.bfloat16) * 0.05)(512) * 16.0),
    }

def reference(A_x, A_k_cache, A_v_cache, A_wq, A_wo, B_x, B_w1, B_b1, B_w2, B_b2, gate_w):
    def _A_ref(x, k_cache, v_cache, wq, wo):
        B, Sq, D = x.shape
        Hq, Dh = 32, 128
        Hkv = k_cache.shape[1]
        rep = Hq // Hkv
        q = (lambda x, *d: x.permute(*d))((x @ wq).reshape(B, Sq, Hq, Dh), 0, 2, 1, 3)
        k = (lambda x, n, axis: torch.repeat_interleave(x, n, dim=axis))(k_cache, rep, axis=1)
        v = (lambda x, n, axis: torch.repeat_interleave(x, n, dim=axis))(v_cache, rep, axis=1)
        scores = torch.einsum("bhqd,bhkd->bhqk", q, k) * (Dh ** -0.5)
        p = _softmax(scores, axis=-1)
        o = torch.einsum("bhqk,bhkd->bhqd", p, v)
        return (lambda x, *d: x.permute(*d))(o, 0, 2, 1, 3).reshape(B, Sq, Hq * Dh) @ wo

    def _B_ref(x, w1, b1, w2, b2):
        h = torch.einsum("bsd,df->bsf", x, w1) + b1
        zero = torch.zeros_like(h)
        r = torch.where(h > zero, h, zero)
        h = r * r
        out = torch.einsum("bsf,fd->bsd", h, w2) + b2
        return out

    x = A_x
    g = _sigmoid((x * gate_w).sum(-1, keepdims=True))
    a = _A_ref(x, A_k_cache, A_v_cache, A_wq, A_wo)
    b = _B_ref(x, B_w1, B_b1, B_w2, B_b2)
    return g * a + (1 - g) * b
```

```asm
; @launch grid=(256,1,1) block=(512,1,1) lds=158080
.amdgcn_target "amdgcn-amd-amdhsa--gfx950"
.text
.globl gated_mix__gqa_block_cached__dense_activation_squared_relu__decode_kernel
.p2align 8
.type gated_mix__gqa_block_cached__dense_activation_squared_relu__decode_kernel,@function
gated_mix__gqa_block_cached__dense_activation_squared_relu__decode_kernel:
    s_cmp_ge_u32 s2, 256
    s_cbranch_scc1 L_end
    s_load_dwordx16 s[16:31], s[0:1], 0
    s_load_dwordx8 s[32:39], s[0:1], 64
    s_load_dwordx4 s[40:43], s[0:1], 96
    v_lshrrev_b32 v1, 6, v0
    v_and_b32 v0, 63, v0
    v_readfirstlane_b32 s3, v1
    v_lshrrev_b32 v6, 4, v0
    v_and_b32 v7, 15, v0
    v_lshlrev_b32 v5, 4, v0
    s_and_b32 s11, s2, 0xe0
    s_and_b32 s6, s2, 7
    s_lshl_b32 s6, s6, 2
    s_add_u32 s11, s11, s6
    s_bfe_u32 s6, s2, 0x20003
    s_add_u32 s11, s11, s6
    s_cmp_lt_u32 s3, 4
    s_cbranch_scc1 L_stream
    s_setprio 3
    v_mov_b32 v10, 0x264c0
    v_mov_b32 v12, 0
    v_mov_b32 v13, 0
    v_mov_b32 v14, 0
    v_mov_b32 v15, 0
    ds_write_b128 v10, v[12:15]
    ds_write_b128 v10, v[12:15] offset:16
    s_getreg_b32 s91, hwreg(HW_REG_XCC_ID)
    s_sub_u32 s3, s3, 4
    v_lshrrev_b32 v16, 3, v0
    v_and_b32 v8, 7, v0
    v_lshlrev_b32 v1, 13, v16
    v_lshl_add_u32 v1, v8, 4, v1
    v_add_u32 v2, 64512, v1
    v_add_u32 v3, 129024, v1
    v_add_u32 v4, 193536, v1
    v_mul_u32_u24 v16, 3584, v16
    v_lshl_add_u32 v16, v8, 4, v16
    v_add_u32 v17, 27648, v16
    v_lshlrev_b32 v18, 10, v8
    v_lshl_add_u32 v19, v6, 3, v18
    v_lshl_add_u32 v18, v6, 4, v18
    s_bfe_u32 s61, s2, 0x20003
    s_and_b32 s60, s2, 7
    s_lshl_b32 s60, s60, 3
    s_lshr_b32 s6, s2, 5
    s_add_u32 s60, s60, s6
    s_lshl_b32 s62, s61, 20
    s_lshl_b32 s6, s60, 7
    s_add_u32 s62, s62, s6
    s_lshl_b32 s6, s3, 18
    s_add_u32 s62, s62, s6
    s_lshl_b32 s6, s3, 12
    s_add_u32 s67, s6, 0x20000
    s_lshl_b32 s6, s3, 11
    s_add_u32 s68, s6, 0x24000
    s_lshl_b32 s63, s61, 8
    s_lshl_b32 s6, s3, 6
    s_add_u32 s63, s63, s6
    s_lshr_b32 s66, s60, 1
    s_and_b32 s69, s60, 1
    s_lshl_b32 s70, s61, 1
    s_add_u32 s70, s70, s69
    s_lshl_b32 s6, s70, 2
    s_add_u32 s6, s6, s3
    s_mul_i32 s65, s6, 57344
    s_lshl_b32 s64, s6, 5
    s_lshl_b32 s6, s66, 7
    s_add_u32 s65, s65, s6
    s_mov_b32 m0, s67
    s_waitcnt lgkmcnt(0)
    s_mov_b32 s48, s22
    s_mov_b32 s49, s23
    s_mov_b32 s50, 0x400000
    s_mov_b32 s51, 0x00020000
    s_mov_b32 s52, s16
    s_mov_b32 s53, s17
    s_mov_b32 s54, 0x2000
    s_mov_b32 s55, 0x00020000
    buffer_load_dwordx4 v1, s[48:51], s62 offen offset:0 nt lds
    buffer_load_dwordx4 v2, s[48:51], s62 offen offset:1024 nt lds
    buffer_load_dwordx4 v3, s[48:51], s62 offen offset:2048 nt lds
    buffer_load_dwordx4 v4, s[48:51], s62 offen offset:3072 nt lds
    buffer_load_dwordx4 v[64:67], v18, s[52:55], s63 offen
    s_mov_b32 m0, s68
    s_mov_b32 s56, s28
    s_mov_b32 s57, s29
    s_mov_b32 s58, 0x1c0000
    s_mov_b32 s59, 0x00020000
    s_cmp_ge_u32 s66, 28
    s_cbranch_scc1 L_now1a
    buffer_load_dwordx4 v16, s[56:59], s65 offen nt lds
    buffer_load_dwordx4 v17, s[56:59], s65 offen offset:1024 nt lds
    buffer_load_dwordx2 v[68:69], v19, s[52:55], s64 offen
L_now1a:
    s_load_dword s4, s[42:43], 0
    s_mov_b32 s95, 0x380000
    s_load_dword s94, s[42:43], s95
    s_barrier
    s_mov_b32 s44, s42
    s_mov_b32 s45, s43
    s_mov_b32 s46, 0x10000000
    s_mov_b32 s47, 0x00020000
    v_lshrrev_b32 v16, 2, v7
    v_and_b32 v9, 3, v0
    v_lshl_add_u32 v17, v6, 3, v16
    v_lshlrev_b32 v11, 7, v17
    v_lshl_add_u32 v11, v9, 3, v11
    v_add_u32 v3, s67, v11
    v_lshl_add_u32 v17, v6, 2, v16
    v_lshlrev_b32 v2, 7, v17
    v_lshl_add_u32 v2, v9, 3, v2
    v_add_u32 v2, s68, v2
    v_mov_b32 v20, 1
    v_xor_b32 v1, v6, v8
    v_lshlrev_b32 v1, 4, v1
    v_lshl_add_u32 v1, v8, 8, v1
    v_add_u32 v1, s67, v1
    v_xor_b32 v19, 64, v1
    v_and_b32 v16, 1, v6
    s_lshl_b32 s6, s3, 1
    v_add_u32 v16, s6, v16
    v_xor_b32 v17, v16, v7
    v_lshlrev_b32 v17, 4, v17
    v_lshl_add_u32 v16, v16, 8, v17
    v_bfe_u32 v17, v0, 3, 2
    s_lshl_b32 s6, s3, 2
    v_add_u32 v17, s6, v17
    v_xor_b32 v17, v17, v8
    v_lshlrev_b32 v17, 4, v17
    v_lshl_add_u32 v18, v8, 8, v17
    v_add_u32 v18, 2048, v18
    s_mov_b32 s6, 0
    s_mov_b32 s7, -1
    v_cndmask_b32 v16, v16, v18, s[6:7]
    v_add_u32 v16, 0x20000, v16
    v_and_b32 v17, 1, v6
    v_mul_u32_u24 v17, 65536, v17
    v_lshl_add_u32 v17, v7, 4, v17
    s_lshl_b32 s63, s3, 6
    s_lshr_b32 s8, s60, 1
    s_add_u32 s63, s63, s8
    s_mul_i32 s63, s63, 2048
    s_lshl_b32 s8, s61, 9
    s_add_u32 s63, s63, s8
    s_lshl_b32 s8, s69, 8
    s_add_u32 s63, s63, s8
    s_add_u32 s63, s63, 0x100000
    v_add_u32 v17, s63, v17
    s_mul_i32 s64, s66, 16384
    s_lshl_b32 s8, s70, 9
    s_add_u32 s64, s64, s8
    s_lshl_b32 s8, s3, 12
    s_add_u32 s64, s64, s8
    s_add_u32 s64, s64, 0x7fe00
    v_add_u32 v18, s64, v5
    v_cndmask_b32 v4, v17, v18, s[6:7]
    s_cmp_lt_u32 s66, 28
    s_cselect_b32 s9, -1, 0
    s_waitcnt lgkmcnt(0)
    s_add_u32 s4, s4, 0x9abcde8
    s_add_u32 s94, s94, 0x2468ad0
    s_add_u32 s5, s4, s94
    s_and_b32 s5, s5, 0xfffffff8
    s_and_b32 s91, s91, 7
    s_or_b32 s91, s91, s5
    v_mov_b32 v113, s91
    v_mov_b32 v115, s91
    s_waitcnt vmcnt(0)
    ds_read_b64_tr_b16 v[128:129], v3 offset:0
    ds_read_b64_tr_b16 v[130:131], v3 offset:512
    ds_read_b64_tr_b16 v[132:133], v3 offset:32
    ds_read_b64_tr_b16 v[134:135], v3 offset:544
    ds_read_b64_tr_b16 v[136:137], v3 offset:64
    ds_read_b64_tr_b16 v[138:139], v3 offset:576
    ds_read_b64_tr_b16 v[140:141], v3 offset:96
    ds_read_b64_tr_b16 v[142:143], v3 offset:608
    ds_read_b64_tr_b16 v[144:145], v2 offset:0
    ds_read_b64_tr_b16 v[146:147], v2 offset:32
    ds_read_b64_tr_b16 v[148:149], v2 offset:64
    ds_read_b64_tr_b16 v[150:151], v2 offset:96
    s_waitcnt lgkmcnt(10)
    v_mfma_f32_16x16x32_bf16 v[80:83], v[128:131], v[64:67], 0
    s_waitcnt lgkmcnt(8)
    v_mfma_f32_16x16x32_bf16 v[84:87], v[132:135], v[64:67], 0
    s_waitcnt lgkmcnt(6)
    v_mfma_f32_16x16x32_bf16 v[88:91], v[136:139], v[64:67], 0
    s_waitcnt lgkmcnt(4)
    v_mfma_f32_16x16x32_bf16 v[92:95], v[140:143], v[64:67], 0
    s_waitcnt lgkmcnt(3)
    v_mfma_f32_16x16x16_bf16 v[96:99], v[144:145], v[68:69], 0
    s_waitcnt lgkmcnt(2)
    v_mfma_f32_16x16x16_bf16 v[100:103], v[146:147], v[68:69], 0
    s_waitcnt lgkmcnt(1)
    v_mfma_f32_16x16x16_bf16 v[104:107], v[148:149], v[68:69], 0
    s_waitcnt lgkmcnt(0)
    v_mfma_f32_16x16x16_bf16 v[108:111], v[150:151], v[68:69], 0
    s_mov_b32 exec_lo, 0x00ff00ff
    s_mov_b32 exec_hi, 0x00ff00ff
    ds_write_b128 v1, v[80:83] offset:0
    ds_write_b128 v19, v[84:87] offset:0
    ds_write_b128 v1, v[88:91] offset:128
    ds_write_b128 v19, v[92:95] offset:128
    ds_write_b128 v1, v[96:99] offset:2048
    ds_write_b128 v19, v[100:103] offset:2048
    ds_write_b128 v1, v[104:107] offset:2176
    ds_write_b128 v19, v[108:111] offset:2176
    s_mov_b64 exec, 1
    s_waitcnt lgkmcnt(0)
    ds_add_u32 v10, v20
    s_mov_b64 exec, -1
    s_mov_b32 s65, 1600000
L_s1:
    ds_read_b32 v21, v10 offset:0
    s_waitcnt lgkmcnt(0)
    v_cmp_gt_u32 vcc, 4, v21
    s_nop 0
    s_cbranch_vccz L_s1_go
    s_sub_u32 s65, s65, 1
    s_cbranch_scc0 L_s1
L_s1_go:
    ds_read_b128 v[32:35], v16 offset:0
    ds_read_b128 v[36:39], v16 offset:4096
    ds_read_b128 v[40:43], v16 offset:8192
    ds_read_b128 v[44:47], v16 offset:12288
    s_waitcnt lgkmcnt(2)
    v_add_f32 v32, v32, v36
    v_add_f32 v33, v33, v37
    v_add_f32 v34, v34, v38
    v_add_f32 v35, v35, v39
    s_waitcnt lgkmcnt(0)
    v_add_f32 v40, v40, v44
    v_add_f32 v41, v41, v45
    v_add_f32 v42, v42, v46
    v_add_f32 v43, v43, v47
    v_add_f32 v32, v32, v40
    v_add_f32 v33, v33, v41
    v_add_f32 v34, v34, v42
    v_add_f32 v35, v35, v43
    v_cvt_pk_bf16_f32 v112, v32, v33
    v_cvt_pk_bf16_f32 v114, v34, v35
    v_mov_b32 v116, v4
    s_mov_b32 s92, 0
    s_mov_b32 exec_hi, s9
    buffer_store_dwordx4 v[112:115], v116, s[44:47], 0 offen
    s_mov_b64 exec, -1
    s_branch L_helper2
L_stream:
    v_lshlrev_b32 v1, 2, v6
    v_xor_b32 v1, v1, v7
    v_xor_b32 v2, 1, v1
    v_xor_b32 v3, 2, v1
    v_xor_b32 v4, 3, v1
    v_lshlrev_b32 v8, 8, v6
    v_lshl_add_u32 v1, v1, 4, v8
    v_lshl_add_u32 v2, v2, 4, v8
    v_lshl_add_u32 v3, v3, 4, v8
    v_lshl_add_u32 v4, v4, 4, v8
    s_lshl_b32 s7, s11, 18
    s_add_u32 s6, s3, 0
    s_and_b32 s6, s6, 3
    s_lshl_b32 s6, s6, 12
    s_add_u32 s12, s7, s6
    s_add_u32 s6, s3, 0
    s_and_b32 s6, s6, 3
    s_lshl_b32 s6, s6, 12
    s_add_u32 s13, s7, s6
    s_add_u32 s6, s3, 0
    s_and_b32 s6, s6, 3
    s_lshl_b32 s6, s6, 12
    s_add_u32 s14, s7, s6
    s_add_u32 s6, s3, 0
    s_and_b32 s6, s6, 3
    s_lshl_b32 s6, s6, 12
    s_add_u32 s15, s7, s6
    s_mov_b32 s60, s12
    s_mov_b32 s61, s12
    s_lshl_b32 s62, s3, 15
    s_waitcnt lgkmcnt(0)
    s_mov_b32 s48, s18
    s_mov_b32 s49, s19
    s_mov_b32 s50, 0x4000000
    s_mov_b32 s51, 0x00020000
    s_mov_b32 s52, s20
    s_mov_b32 s53, s21
    s_mov_b32 s54, 0x4000000
    s_mov_b32 s55, 0x00020000
    s_load_dword s4, s[42:43], 0
    s_mov_b32 s95, 0x380000
    s_load_dword s94, s[42:43], s95
    s_add_u32 m0, s62, 0
    s_nop 0
    buffer_load_dwordx4 v1, s[48:51], s60 offen offset:0 nt lds
    buffer_load_dwordx4 v2, s[48:51], s60 offen offset:1024 nt lds
    buffer_load_dwordx4 v3, s[48:51], s60 offen offset:2048 nt lds
    buffer_load_dwordx4 v4, s[48:51], s60 offen offset:3072 nt lds
    s_add_u32 s60, s13, 16384
    s_barrier
    s_setprio 2
    s_mov_b32 s44, s42
    s_mov_b32 s45, s43
    s_mov_b32 s46, 0x10000000
    s_mov_b32 s47, 0x00020000
    v_and_b32 v8, 3, v7
    v_lshlrev_b32 v8, 10, v8
    v_lshrrev_b32 v9, 2, v7
    v_lshl_add_u32 v8, v9, 8, v8
    v_add_u32 v8, s62, v8
    v_xor_b32 v9, v6, v7
    v_and_b32 v44, 3, v7
    v_lshlrev_b32 v44, 8, v44
    v_lshl_add_u32 v44, v6, 4, v44
    v_add_u32 v44, 0x26000, v44
    v_xor_b32 v45, 4, v9
    v_xor_b32 v46, 8, v9
    v_xor_b32 v47, 12, v9
    v_lshl_add_u32 v6, v9, 4, v8
    v_lshl_add_u32 v7, v45, 4, v8
    v_lshl_add_u32 v9, v47, 4, v8
    v_lshl_add_u32 v8, v46, 4, v8
    s_mov_b32 s64, 0x00f000f0
    s_mov_b32 s65, 0x00f000f0
    s_mov_b32 s66, 0x0f000f00
    s_mov_b32 s67, 0x0f000f00
    s_mov_b32 s70, 0xf000f000
    s_mov_b32 s71, 0xf000f000
    s_mov_b32 s8, 0x05040100
    s_mov_b32 s9, 0x07060302
    s_mov_b32 s10, 0x3e0293ee
    v_mov_b32 v45, 0x264c0
    v_mov_b32 v46, 1
    s_mov_b32 s56, s34
    s_mov_b32 s57, s35
    s_mov_b32 s58, 0x400
    s_mov_b32 s59, 0x00020000
    s_and_b32 s6, s11, 31
    s_lshr_b32 s6, s6, 1
    s_lshl_b32 s6, s6, 5
    s_and_b32 s7, s11, 1
    s_lshl_b32 s7, s7, 3
    s_add_u32 s69, s6, s7
    s_lshl_b32 s68, s69, 1
    v_and_b32 v12, 7, v0
    v_lshlrev_b32 v12, 1, v12
    s_add_u32 m0, s62, 4096
    s_nop 0
    buffer_load_dwordx4 v1, s[48:51], s60 offen offset:0 nt lds
    buffer_load_dwordx4 v2, s[48:51], s60 offen offset:1024 nt lds
    s_waitcnt vmcnt(5)
    buffer_load_dwordx4 v3, s[48:51], s60 offen offset:2048 nt lds
    s_waitcnt vmcnt(5)
    buffer_load_dwordx4 v4, s[48:51], s60 offen offset:3072 nt lds
    s_add_u32 s60, s14, 32768
    s_add_u32 m0, s62, 8192
    s_waitcnt vmcnt(5)
    buffer_load_dwordx4 v1, s[48:51], s60 offen offset:0 nt lds
    s_waitcnt vmcnt(5)
    buffer_load_dwordx4 v2, s[48:51], s60 offen offset:1024 nt lds
    s_waitcnt vmcnt(5)
    buffer_load_dwordx4 v3, s[48:51], s60 offen offset:2048 nt lds
    s_waitcnt vmcnt(5)
    buffer_load_dwordx4 v4, s[48:51], s60 offen offset:3072 nt lds
    s_add_u32 s60, s15, 49152
    s_add_u32 m0, s62, 12288
    s_waitcnt vmcnt(5)
    buffer_load_dwordx4 v1, s[48:51], s60 offen offset:0 nt lds
    s_waitcnt vmcnt(5)
    buffer_load_dwordx4 v2, s[48:51], s60 offen offset:1024 nt lds
    s_waitcnt vmcnt(5)
    buffer_load_dwordx4 v3, s[48:51], s60 offen offset:2048 nt lds
    s_waitcnt vmcnt(5)
    buffer_load_dwordx4 v4, s[48:51], s60 offen offset:3072 nt lds
    s_add_u32 s60, s12, 65536
    s_add_u32 m0, s62, 16384
    s_waitcnt vmcnt(5)
    buffer_load_dwordx4 v1, s[48:51], s60 offen offset:0 nt lds
    s_waitcnt vmcnt(5)
    buffer_load_dwordx4 v2, s[48:51], s60 offen offset:1024 nt lds
    s_waitcnt vmcnt(5)
    buffer_load_dwordx4 v3, s[48:51], s60 offen offset:2048 nt lds
    s_waitcnt vmcnt(5)
    buffer_load_dwordx4 v4, s[48:51], s60 offen offset:3072 nt lds
    s_add_u32 s60, s13, 81920
    s_add_u32 m0, s62, 20480
    s_waitcnt vmcnt(5)
    buffer_load_dwordx4 v1, s[48:51], s60 offen offset:0 nt lds
    s_waitcnt vmcnt(5)
    buffer_load_dwordx4 v2, s[48:51], s60 offen offset:1024 nt lds
    s_waitcnt vmcnt(5)
    buffer_load_dwordx4 v3, s[48:51], s60 offen offset:2048 nt lds
    s_waitcnt vmcnt(5)
    buffer_load_dwordx4 v4, s[48:51], s60 offen offset:3072 nt lds
    s_add_u32 s60, s14, 98304
    s_add_u32 m0, s62, 24576
    s_waitcnt vmcnt(5)
    buffer_load_dwordx4 v1, s[48:51], s60 offen offset:0 nt lds
    s_waitcnt vmcnt(5)
    buffer_load_dwordx4 v2, s[48:51], s60 offen offset:1024 nt lds
    s_waitcnt vmcnt(5)
    buffer_load_dwordx4 v3, s[48:51], s60 offen offset:2048 nt lds
    s_waitcnt vmcnt(5)
    buffer_load_dwordx4 v4, s[48:51], s60 offen offset:3072 nt lds
    s_add_u32 s60, s15, 114688
    s_mov_b64 exec, 1
    ds_add_u32 v45, v46 offset:16
    s_mov_b64 exec, -1
    s_add_u32 m0, s62, 28672
    s_waitcnt vmcnt(5)
    buffer_load_dwordx4 v1, s[48:51], s60 offen offset:0 nt lds
    s_waitcnt vmcnt(5)
    buffer_load_dwordx4 v2, s[48:51], s60 offen offset:1024 nt lds
    s_waitcnt vmcnt(5)
    buffer_load_dwordx4 v3, s[48:51], s60 offen offset:2048 nt lds
    s_waitcnt vmcnt(5)
    buffer_load_dwordx4 v4, s[48:51], s60 offen offset:3072 nt lds
    s_add_u32 s60, s12, 131072
    buffer_load_ushort v10, v12, s[56:59], s68 offen
    buffer_load_ushort v11, v12, s[56:59], s68 offen offset:32
    s_waitcnt vmcnt(5)
    buffer_load_dwordx4 v[64:67], v5, s[52:55], s61 offen offset:0 nt
    s_waitcnt vmcnt(5)
    buffer_load_dwordx4 v[68:71], v5, s[52:55], s61 offen offset:1024 nt
    s_waitcnt vmcnt(5)
    buffer_load_dwordx4 v[72:75], v5, s[52:55], s61 offen offset:2048 nt
    s_waitcnt vmcnt(5)
    buffer_load_dwordx4 v[76:79], v5, s[52:55], s61 offen offset:3072 nt
    s_add_u32 s61, s13, 16384
    s_waitcnt vmcnt(5)
    buffer_load_dwordx4 v[80:83], v5, s[52:55], s61 offen offset:0 nt
    s_waitcnt vmcnt(5)
    buffer_load_dwordx4 v[84:87], v5, s[52:55], s61 offen offset:1024 nt
    s_waitcnt vmcnt(5)
    buffer_load_dwordx4 v[88:91], v5, s[52:55], s61 offen offset:2048 nt
    s_waitcnt vmcnt(5)
    buffer_load_dwordx4 v[92:95], v5, s[52:55], s61 offen offset:3072 nt
    s_add_u32 s61, s14, 32768
    s_waitcnt vmcnt(5)
    buffer_load_dwordx4 v[96:99], v5, s[52:55], s61 offen offset:0 nt
    s_waitcnt vmcnt(5)
    buffer_load_dwordx4 v[100:103], v5, s[52:55], s61 offen offset:1024 nt
    s_waitcnt vmcnt(5)
    buffer_load_dwordx4 v[104:107], v5, s[52:55], s61 offen offset:2048 nt
    s_waitcnt vmcnt(5)
    buffer_load_dwordx4 v[108:111], v5, s[52:55], s61 offen offset:3072 nt
    s_add_u32 s61, s15, 49152
    s_waitcnt lgkmcnt(0)
    s_add_u32 s4, s4, 0x9abcde8
    s_add_u32 s94, s94, 0x2468ad0
    s_add_u32 s5, s4, s94
    s_and_b32 s5, s5, 0xfffffff8
    s_mov_b32 s63, 1600000
L_wq:
    ds_read_b32 v46, v45 offset:4
    s_waitcnt lgkmcnt(0)
    v_cmp_gt_u32 vcc, 4, v46
    s_nop 0
    s_cbranch_vccz L_wq_go
    s_sub_u32 s63, s63, 1
    s_cbranch_scc0 L_wq
L_wq_go:
    ds_read_b128 v[12:15], v44 offset:0
    ds_read_b128 v[16:19], v44 offset:64
    ds_read_b128 v[20:23], v44 offset:128
    ds_read_b128 v[24:27], v44 offset:192
    s_waitcnt vmcnt(5)
    buffer_load_dwordx4 v[112:115], v5, s[52:55], s61 offen offset:0 nt
    ds_read_b128 v[28:31], v6 offset:0
    ds_read_b128 v[32:35], v7 offset:0
    ds_read_b128 v[36:39], v8 offset:0
    ds_read_b128 v[40:43], v9 offset:0
    s_waitcnt vmcnt(5)
    buffer_load_dwordx4 v[116:119], v5, s[52:55], s61 offen offset:1024 nt
    s_waitcnt lgkmcnt(3)
    v_mfma_f32_16x16x32_bf16 v[48:51], v[28:31], v[12:15], 0
    s_waitcnt lgkmcnt(2)
    v_mfma_f32_16x16x32_bf16 v[48:51], v[32:35], v[16:19], v[48:51]
    s_waitcnt lgkmcnt(1)
    v_mfma_f32_16x16x32_bf16 v[48:51], v[36:39], v[20:23], v[48:51]
    s_waitcnt lgkmcnt(0)
    v_mfma_f32_16x16x32_bf16 v[48:51], v[40:43], v[24:27], v[48:51]
    s_waitcnt vmcnt(5)
    buffer_load_dwordx4 v[120:123], v5, s[52:55], s61 offen offset:2048 nt
    ds_read_b128 v[28:31], v6 offset:4096
    ds_read_b128 v[32:35], v7 offset:4096
    ds_read_b128 v[36:39], v8 offset:4096
    ds_read_b128 v[40:43], v9 offset:4096
    s_waitcnt vmcnt(5)
    buffer_load_dwordx4 v[124:127], v5, s[52:55], s61 offen offset:3072 nt
    s_add_u32 s61, s12, 65536
    s_waitcnt lgkmcnt(3)
    v_mfma_f32_16x16x32_bf16 v[52:55], v[28:31], v[12:15], 0
    s_waitcnt lgkmcnt(2)
    v_mfma_f32_16x16x32_bf16 v[52:55], v[32:35], v[16:19], v[52:55]
    s_waitcnt lgkmcnt(1)
    v_mfma_f32_16x16x32_bf16 v[52:55], v[36:39], v[20:23], v[52:55]
    s_waitcnt lgkmcnt(0)
    v_mfma_f32_16x16x32_bf16 v[52:55], v[40:43], v[24:27], v[52:55]
    s_add_u32 m0, s62, 0
    s_waitcnt vmcnt(5)
    buffer_load_dwordx4 v1, s[48:51], s60 offen offset:0 nt lds
    ds_read_b128 v[28:31], v6 offset:8192
    ds_read_b128 v[32:35], v7 offset:8192
    ds_read_b128 v[36:39], v8 offset:8192
    ds_read_b128 v[40:43], v9 offset:8192
    s_waitcnt vmcnt(5)
    buffer_load_dwordx4 v2, s[48:51], s60 offen offset:1024 nt lds
    s_waitcnt lgkmcnt(3)
    v_mfma_f32_16x16x32_bf16 v[44:47], v[28:31], v[12:15], 0
    s_waitcnt lgkmcnt(2)
    v_mfma_f32_16x16x32_bf16 v[44:47], v[32:35], v[16:19], v[44:47]
    s_waitcnt lgkmcnt(1)
    v_mfma_f32_16x16x32_bf16 v[44:47], v[36:39], v[20:23], v[44:47]
    s_waitcnt lgkmcnt(0)
    v_mfma_f32_16x16x32_bf16 v[44:47], v[40:43], v[24:27], v[44:47]
    s_waitcnt vmcnt(5)
    buffer_load_dwordx4 v3, s[48:51], s60 offen offset:2048 nt lds
    ds_read_b128 v[28:31], v6 offset:12288
    ds_read_b128 v[32:35], v7 offset:12288
    ds_read_b128 v[36:39], v8 offset:12288
    ds_read_b128 v[40:43], v9 offset:12288
    s_nop 1
    v_cndmask_b32 v48, v48, v44, s[64:65]
    v_cndmask_b32 v49, v49, v45, s[64:65]
    v_cndmask_b32 v50, v50, v46, s[64:65]
    v_cndmask_b32 v51, v51, v47, s[64:65]
    s_waitcnt vmcnt(5)
    buffer_load_dwordx4 v4, s[48:51], s60 offen offset:3072 nt lds
    s_add_u32 s60, s13, 147456
    s_waitcnt lgkmcnt(3)
    v_mfma_f32_16x16x32_bf16 v[44:47], v[28:31], v[12:15], 0
    s_waitcnt lgkmcnt(2)
    v_mfma_f32_16x16x32_bf16 v[44:47], v[32:35], v[16:19], v[44:47]
    s_waitcnt lgkmcnt(1)
    v_mfma_f32_16x16x32_bf16 v[44:47], v[36:39], v[20:23], v[44:47]
    s_waitcnt lgkmcnt(0)
    v_mfma_f32_16x16x32_bf16 v[44:47], v[40:43], v[24:27], v[44:47]
    s_add_u32 m0, s62, 4096
    s_waitcnt vmcnt(5)
    buffer_load_dwordx4 v1, s[48:51], s60 offen offset:0 nt lds
    ds_read_b128 v[28:31], v6 offset:16384
    ds_read_b128 v[32:35], v7 offset:16384
    ds_read_b128 v[36:39], v8 offset:16384
    ds_read_b128 v[40:43], v9 offset:16384
    s_nop 0
    v_cndmask_b32 v52, v52, v44, s[64:65]
    v_cndmask_b32 v53, v53, v45, s[64:65]
    v_cndmask_b32 v54, v54, v46, s[64:65]
    v_cndmask_b32 v55, v55, v47, s[64:65]
    s_waitcnt vmcnt(5)
    buffer_load_dwordx4 v2, s[48:51], s60 offen offset:1024 nt lds
    s_waitcnt lgkmcnt(3)
    v_mfma_f32_16x16x32_bf16 v[44:47], v[28:31], v[12:15], 0
    s_waitcnt lgkmcnt(2)
    v_mfma_f32_16x16x32_bf16 v[44:47], v[32:35], v[16:19], v[44:47]
    s_waitcnt lgkmcnt(1)
    v_mfma_f32_16x16x32_bf16 v[44:47], v[36:39], v[20:23], v[44:47]
    s_waitcnt lgkmcnt(0)
    v_mfma_f32_16x16x32_bf16 v[44:47], v[40:43], v[24:27], v[44:47]
    s_waitcnt vmcnt(5)
    buffer_load_dwordx4 v3, s[48:51], s60 offen offset:2048 nt lds
    ds_read_b128 v[28:31], v6 offset:20480
    ds_read_b128 v[32:35], v7 offset:20480
    ds_read_b128 v[36:39], v8 offset:20480
    ds_read_b128 v[40:43], v9 offset:20480
    s_nop 1
    v_cndmask_b32 v48, v48, v44, s[66:67]
    v_cndmask_b32 v49, v49, v45, s[66:67]
    v_cndmask_b32 v50, v50, v46, s[66:67]
    v_cndmask_b32 v51, v51, v47, s[66:67]
    s_waitcnt vmcnt(5)
    buffer_load_dwordx4 v4, s[48:51], s60 offen offset:3072 nt lds
    s_add_u32 s60, s14, 163840
    s_waitcnt lgkmcnt(3)
    v_mfma_f32_16x16x32_bf16 v[44:47], v[28:31], v[12:15], 0
    s_waitcnt lgkmcnt(2)
    v_mfma_f32_16x16x32_bf16 v[44:47], v[32:35], v[16:19], v[44:47]
    s_waitcnt lgkmcnt(1)
    v_mfma_f32_16x16x32_bf16 v[44:47], v[36:39], v[20:23], v[44:47]
    s_waitcnt lgkmcnt(0)
    v_mfma_f32_16x16x32_bf16 v[44:47], v[40:43], v[24:27], v[44:47]
    s_add_u32 m0, s62, 8192
    s_waitcnt vmcnt(5)
    buffer_load_dwordx4 v1, s[48:51], s60 offen offset:0 nt lds
    ds_read_b128 v[28:31], v6 offset:24576
    ds_read_b128 v[32:35], v7 offset:24576
    ds_read_b128 v[36:39], v8 offset:24576
    ds_read_b128 v[40:43], v9 offset:24576
    s_nop 0
    v_cndmask_b32 v52, v52, v44, s[66:67]
    v_cndmask_b32 v53, v53, v45, s[66:67]
    v_cndmask_b32 v54, v54, v46, s[66:67]
    v_cndmask_b32 v55, v55, v47, s[66:67]
    s_waitcnt vmcnt(5)
    buffer_load_dwordx4 v2, s[48:51], s60 offen offset:1024 nt lds
    s_waitcnt lgkmcnt(3)
    v_mfma_f32_16x16x32_bf16 v[44:47], v[28:31], v[12:15], 0
    s_waitcnt lgkmcnt(2)
    v_mfma_f32_16x16x32_bf16 v[44:47], v[32:35], v[16:19], v[44:47]
    s_waitcnt lgkmcnt(1)
    v_mfma_f32_16x16x32_bf16 v[44:47], v[36:39], v[20:23], v[44:47]
    s_waitcnt lgkmcnt(0)
    v_mfma_f32_16x16x32_bf16 v[44:47], v[40:43], v[24:27], v[44:47]
    s_waitcnt vmcnt(5)
    buffer_load_dwordx4 v3, s[48:51], s60 offen offset:2048 nt lds
    ds_read_b128 v[28:31], v6 offset:28672
    ds_read_b128 v[32:35], v7 offset:28672
    ds_read_b128 v[36:39], v8 offset:28672
    ds_read_b128 v[40:43], v9 offset:28672
    s_nop 1
    v_cndmask_b32 v48, v48, v44, s[70:71]
    v_cndmask_b32 v49, v49, v45, s[70:71]
    v_cndmask_b32 v50, v50, v46, s[70:71]
    v_cndmask_b32 v51, v51, v47, s[70:71]
    s_waitcnt vmcnt(5)
    buffer_load_dwordx4 v4, s[48:51], s60 offen offset:3072 nt lds
    s_add_u32 s60, s15, 180224
    s_waitcnt lgkmcnt(3)
    v_mfma_f32_16x16x32_bf16 v[44:47], v[28:31], v[12:15], 0
    s_waitcnt lgkmcnt(2)
    v_mfma_f32_16x16x32_bf16 v[44:47], v[32:35], v[16:19], v[44:47]
    s_waitcnt lgkmcnt(1)
    v_mfma_f32_16x16x32_bf16 v[44:47], v[36:39], v[20:23], v[44:47]
    s_waitcnt lgkmcnt(0)
    v_mfma_f32_16x16x32_bf16 v[44:47], v[40:43], v[24:27], v[44:47]
    s_add_u32 m0, s62, 12288
    s_waitcnt vmcnt(5)
    buffer_load_dwordx4 v1, s[48:51], s60 offen offset:0 nt lds
    ds_read_b128 v[28:31], v6 offset:0
    ds_read_b128 v[32:35], v7 offset:0
    ds_read_b128 v[36:39], v8 offset:0
    ds_read_b128 v[40:43], v9 offset:0
    s_nop 0
    v_cndmask_b32 v52, v52, v44, s[70:71]
    v_cndmask_b32 v53, v53, v45, s[70:71]
    v_cndmask_b32 v54, v54, v46, s[70:71]
    v_cndmask_b32 v55, v55, v47, s[70:71]
    s_waitcnt vmcnt(5)
    buffer_load_dwordx4 v2, s[48:51], s60 offen offset:1024 nt lds
    s_waitcnt lgkmcnt(3)
    v_mfma_f32_16x16x32_bf16 v[56:59], v[28:31], v[12:15], 0
    s_waitcnt lgkmcnt(2)
    v_mfma_f32_16x16x32_bf16 v[56:59], v[32:35], v[16:19], v[56:59]
    s_waitcnt lgkmcnt(1)
    v_mfma_f32_16x16x32_bf16 v[56:59], v[36:39], v[20:23], v[56:59]
    s_waitcnt lgkmcnt(0)
    v_mfma_f32_16x16x32_bf16 v[56:59], v[40:43], v[24:27], v[56:59]
    s_waitcnt vmcnt(5)
    buffer_load_dwordx4 v3, s[48:51], s60 offen offset:2048 nt lds
    ds_read_b128 v[28:31], v6 offset:4096
    ds_read_b128 v[32:35], v7 offset:4096
    ds_read_b128 v[36:39], v8 offset:4096
    ds_read_b128 v[40:43], v9 offset:4096
    s_waitcnt vmcnt(5)
    buffer_load_dwordx4 v4, s[48:51], s60 offen offset:3072 nt lds
    s_add_u32 s60, s12, 196608
    s_waitcnt lgkmcnt(3)
    v_mfma_f32_16x16x32_bf16 v[60:63], v[28:31], v[12:15], 0
    s_waitcnt lgkmcnt(2)
    v_mfma_f32_16x16x32_bf16 v[60:63], v[32:35], v[16:19], v[60:63]
    s_waitcnt lgkmcnt(1)
    v_mfma_f32_16x16x32_bf16 v[60:63], v[36:39], v[20:23], v[60:63]
    s_waitcnt lgkmcnt(0)
    v_mfma_f32_16x16x32_bf16 v[60:63], v[40:43], v[24:27], v[60:63]
    s_add_u32 m0, s62, 16384
    s_waitcnt vmcnt(5)
    buffer_load_dwordx4 v1, s[48:51], s60 offen offset:0 nt lds
    s_waitcnt vmcnt(5)
    buffer_load_dwordx4 v2, s[48:51], s60 offen offset:1024 nt lds
    ds_read_b128 v[28:31], v6 offset:8192
    ds_read_b128 v[32:35], v7 offset:8192
    ds_read_b128 v[36:39], v8 offset:8192
    ds_read_b128 v[40:43], v9 offset:8192
    s_waitcnt vmcnt(5)
    buffer_load_dwordx4 v3, s[48:51], s60 offen offset:2048 nt lds
    s_waitcnt lgkmcnt(3)
    v_mfma_f32_16x16x32_bf16 v[44:47], v[28:31], v[12:15], 0
    s_waitcnt lgkmcnt(2)
    v_mfma_f32_16x16x32_bf16 v[44:47], v[32:35], v[16:19], v[44:47]
    s_waitcnt lgkmcnt(1)
    v_mfma_f32_16x16x32_bf16 v[44:47], v[36:39], v[20:23], v[44:47]
    s_waitcnt lgkmcnt(0)
    v_mfma_f32_16x16x32_bf16 v[44:47], v[40:43], v[24:27], v[44:47]
    s_waitcnt vmcnt(5)
    buffer_load_dwordx4 v4, s[48:51], s60 offen offset:3072 nt lds
    s_add_u32 s60, s13, 212992
    s_add_u32 m0, s62, 20480
    s_waitcnt vmcnt(5)
    buffer_load_dwordx4 v1, s[48:51], s60 offen offset:0 nt lds
    s_waitcnt vmcnt(5)
    buffer_load_dwordx4 v2, s[48:51], s60 offen offset:1024 nt lds
    ds_read_b128 v[28:31], v6 offset:12288
    ds_read_b128 v[32:35], v7 offset:12288
    ds_read_b128 v[36:39], v8 offset:12288
    ds_read_b128 v[40:43], v9 offset:12288
    v_cndmask_b32 v56, v56, v44, s[64:65]
    v_cndmask_b32 v57, v57, v45, s[64:65]
    v_cndmask_b32 v58, v58, v46, s[64:65]
    v_cndmask_b32 v59, v59, v47, s[64:65]
    s_waitcnt vmcnt(5)
    buffer_load_dwordx4 v3, s[48:51], s60 offen offset:2048 nt lds
    s_waitcnt lgkmcnt(3)
    v_mfma_f32_16x16x32_bf16 v[44:47], v[28:31], v[12:15], 0
    s_waitcnt lgkmcnt(2)
    v_mfma_f32_16x16x32_bf16 v[44:47], v[32:35], v[16:19], v[44:47]
    s_waitcnt lgkmcnt(1)
    v_mfma_f32_16x16x32_bf16 v[44:47], v[36:39], v[20:23], v[44:47]
    s_waitcnt lgkmcnt(0)
    v_mfma_f32_16x16x32_bf16 v[44:47], v[40:43], v[24:27], v[44:47]
    s_waitcnt vmcnt(5)
    buffer_load_dwordx4 v4, s[48:51], s60 offen offset:3072 nt lds
    s_add_u32 s60, s14, 229376
    s_add_u32 m0, s62, 24576
    s_waitcnt vmcnt(5)
    buffer_load_dwordx4 v1, s[48:51], s60 offen offset:0 nt lds
    s_waitcnt vmcnt(5)
    buffer_load_dwordx4 v2, s[48:51], s60 offen offset:1024 nt lds
    ds_read_b128 v[28:31], v6 offset:16384
    ds_read_b128 v[32:35], v7 offset:16384
    ds_read_b128 v[36:39], v8 offset:16384
    ds_read_b128 v[40:43], v9 offset:16384
    v_cndmask_b32 v60, v60, v44, s[64:65]
    v_cndmask_b32 v61, v61, v45, s[64:65]
    v_cndmask_b32 v62, v62, v46, s[64:65]
    v_cndmask_b32 v63, v63, v47, s[64:65]
    s_waitcnt vmcnt(5)
    buffer_load_dwordx4 v3, s[48:51], s60 offen offset:2048 nt lds
    s_waitcnt lgkmcnt(3)
    v_mfma_f32_16x16x32_bf16 v[44:47], v[28:31], v[12:15], 0
    s_waitcnt lgkmcnt(2)
    v_mfma_f32_16x16x32_bf16 v[44:47], v[32:35], v[16:19], v[44:47]
    s_waitcnt lgkmcnt(1)
    v_mfma_f32_16x16x32_bf16 v[44:47], v[36:39], v[20:23], v[44:47]
    s_waitcnt lgkmcnt(0)
    v_mfma_f32_16x16x32_bf16 v[44:47], v[40:43], v[24:27], v[44:47]
    s_waitcnt vmcnt(5)
    buffer_load_dwordx4 v4, s[48:51], s60 offen offset:3072 nt lds
    s_add_u32 s60, s15, 245760
    s_add_u32 m0, s62, 28672
    s_waitcnt vmcnt(5)
    buffer_load_dwordx4 v1, s[48:51], s60 offen offset:0 nt lds
    s_waitcnt vmcnt(5)
    buffer_load_dwordx4 v2, s[48:51], s60 offen offset:1024 nt lds
    ds_read_b128 v[28:31], v6 offset:20480
    ds_read_b128 v[32:35], v7 offset:20480
    ds_read_b128 v[36:39], v8 offset:20480
    ds_read_b128 v[40:43], v9 offset:20480
    v_cndmask_b32 v56, v56, v44, s[66:67]
    v_cndmask_b32 v57, v57, v45, s[66:67]
    v_cndmask_b32 v58, v58, v46, s[66:67]
    v_cndmask_b32 v59, v59, v47, s[66:67]
    s_waitcnt vmcnt(5)
    buffer_load_dwordx4 v3, s[48:51], s60 offen offset:2048 nt lds
    s_waitcnt lgkmcnt(3)
    v_mfma_f32_16x16x32_bf16 v[44:47], v[28:31], v[12:15], 0
    s_waitcnt lgkmcnt(2)
    v_mfma_f32_16x16x32_bf16 v[44:47], v[32:35], v[16:19], v[44:47]
    s_waitcnt lgkmcnt(1)
    v_mfma_f32_16x16x32_bf16 v[44:47], v[36:39], v[20:23], v[44:47]
    s_waitcnt lgkmcnt(0)
    v_mfma_f32_16x16x32_bf16 v[44:47], v[40:43], v[24:27], v[44:47]
    s_waitcnt vmcnt(5)
    buffer_load_dwordx4 v4, s[48:51], s60 offen offset:3072 nt lds
    s_waitcnt vmcnt(5)
    buffer_load_dwordx4 v[128:131], v5, s[52:55], s61 offen offset:0 nt
    s_waitcnt vmcnt(5)
    buffer_load_dwordx4 v[132:135], v5, s[52:55], s61 offen offset:1024 nt
    ds_read_b128 v[28:31], v6 offset:24576
    ds_read_b128 v[32:35], v7 offset:24576
    ds_read_b128 v[36:39], v8 offset:24576
    ds_read_b128 v[40:43], v9 offset:24576
    v_cndmask_b32 v60, v60, v44, s[66:67]
    v_cndmask_b32 v61, v61, v45, s[66:67]
    v_cndmask_b32 v62, v62, v46, s[66:67]
    v_cndmask_b32 v63, v63, v47, s[66:67]
    s_waitcnt vmcnt(5)
    buffer_load_dwordx4 v[136:139], v5, s[52:55], s61 offen offset:2048 nt
    s_waitcnt lgkmcnt(3)
    v_mfma_f32_16x16x32_bf16 v[44:47], v[28:31], v[12:15], 0
    s_waitcnt lgkmcnt(2)
    v_mfma_f32_16x16x32_bf16 v[44:47], v[32:35], v[16:19], v[44:47]
    s_waitcnt lgkmcnt(1)
    v_mfma_f32_16x16x32_bf16 v[44:47], v[36:39], v[20:23], v[44:47]
    s_waitcnt lgkmcnt(0)
    v_mfma_f32_16x16x32_bf16 v[44:47], v[40:43], v[24:27], v[44:47]
    s_waitcnt vmcnt(5)
    buffer_load_dwordx4 v[140:143], v5, s[52:55], s61 offen offset:3072 nt
    s_add_u32 s61, s13, 81920
    s_waitcnt vmcnt(5)
    buffer_load_dwordx4 v[144:147], v5, s[52:55], s61 offen offset:0 nt
    s_waitcnt vmcnt(5)
    buffer_load_dwordx4 v[148:151], v5, s[52:55], s61 offen offset:1024 nt
    ds_read_b128 v[28:31], v6 offset:28672
    ds_read_b128 v[32:35], v7 offset:28672
    ds_read_b128 v[36:39], v8 offset:28672
    ds_read_b128 v[40:43], v9 offset:28672
    v_cndmask_b32 v56, v56, v44, s[70:71]
    v_cndmask_b32 v57, v57, v45, s[70:71]
    v_cndmask_b32 v58, v58, v46, s[70:71]
    v_cndmask_b32 v59, v59, v47, s[70:71]
    s_waitcnt vmcnt(5)
    buffer_load_dwordx4 v[152:155], v5, s[52:55], s61 offen offset:2048 nt
    s_waitcnt lgkmcnt(3)
    v_mfma_f32_16x16x32_bf16 v[44:47], v[28:31], v[12:15], 0
    s_waitcnt lgkmcnt(2)
    v_mfma_f32_16x16x32_bf16 v[44:47], v[32:35], v[16:19], v[44:47]
    s_waitcnt lgkmcnt(1)
    v_mfma_f32_16x16x32_bf16 v[44:47], v[36:39], v[20:23], v[44:47]
    s_waitcnt lgkmcnt(0)
    v_mfma_f32_16x16x32_bf16 v[44:47], v[40:43], v[24:27], v[44:47]
    s_waitcnt vmcnt(5)
    buffer_load_dwordx4 v[156:159], v5, s[52:55], s61 offen offset:3072 nt
    s_add_u32 s61, s14, 98304
    s_nop 4
    v_cndmask_b32 v60, v60, v44, s[70:71]
    v_cndmask_b32 v61, v61, v45, s[70:71]
    v_cndmask_b32 v62, v62, v46, s[70:71]
    v_cndmask_b32 v63, v63, v47, s[70:71]
    v_max3_f32 v44, v48, v49, v50
    v_max3_f32 v45, v51, v52, v53
    v_max3_f32 v46, v54, v55, v56
    v_max3_f32 v47, v57, v58, v59
    v_max3_f32 v44, v44, v60, v61
    v_max3_f32 v45, v45, v62, v63
    v_max3_f32 v44, v44, v46, v47
    v_max_f32 v44, v44, v45
    s_waitcnt vmcnt(5)
    buffer_load_dwordx4 v[160:163], v5, s[52:55], s61 offen offset:0 nt
    v_max_f32_dpp v44, v44, v44 row_ror:4 row_mask:0xf bank_mask:0xf
    s_nop 1
    v_max_f32_dpp v44, v44, v44 row_ror:8 row_mask:0xf bank_mask:0xf
    v_mov_b32 v45, v44
    s_nop 1
    v_permlane16_swap_b32 v44, v45
    v_max_f32 v44, v44, v45
    v_mov_b32 v45, v44
    s_nop 1
    v_permlane32_swap_b32 v44, v45
    v_max_f32 v44, v44, v45
    v_mul_f32 v44, s10, v44
    v_and_b32 v46, 3, v0
    v_lshlrev_b32 v46, 4, v46
    s_lshl_b32 s6, s3, 2
    s_add_u32 s6, s6, 0x26400
    v_add_u32 v47, s6, v46
    s_waitcnt vmcnt(5)
    buffer_load_dwordx4 v[164:167], v5, s[52:55], s61 offen offset:1024 nt
    v_fma_f32 v48, v48, s10, -v44
    v_fma_f32 v49, v49, s10, -v44
    v_fma_f32 v50, v50, s10, -v44
    v_fma_f32 v51, v51, s10, -v44
    v_fma_f32 v52, v52, s10, -v44
    v_fma_f32 v53, v53, s10, -v44
    v_fma_f32 v54, v54, s10, -v44
    v_fma_f32 v55, v55, s10, -v44
    v_exp_f32 v48, v48
    v_exp_f32 v49, v49
    v_exp_f32 v50, v50
    v_exp_f32 v51, v51
    v_exp_f32 v52, v52
    v_exp_f32 v53, v53
    v_exp_f32 v54, v54
    v_exp_f32 v55, v55
    s_waitcnt vmcnt(5)
    buffer_load_dwordx4 v[168:171], v5, s[52:55], s61 offen offset:2048 nt
    v_fma_f32 v56, v56, s10, -v44
    v_fma_f32 v57, v57, s10, -v44
    v_fma_f32 v58, v58, s10, -v44
    v_fma_f32 v59, v59, s10, -v44
    v_fma_f32 v60, v60, s10, -v44
    v_fma_f32 v61, v61, s10, -v44
    v_fma_f32 v62, v62, s10, -v44
    v_fma_f32 v63, v63, s10, -v44
    v_exp_f32 v56, v56
    v_exp_f32 v57, v57
    v_exp_f32 v58, v58
    v_exp_f32 v59, v59
    v_exp_f32 v60, v60
    v_exp_f32 v61, v61
    v_exp_f32 v62, v62
    v_exp_f32 v63, v63
    s_waitcnt vmcnt(5)
    buffer_load_dwordx4 v[172:175], v5, s[52:55], s61 offen offset:3072 nt
    s_add_u32 s61, s15, 114688
    v_add_f32 v28, v48, v49
    v_add_f32 v29, v50, v51
    v_add_f32 v30, v52, v53
    v_add_f32 v31, v54, v55
    v_add_f32 v28, v28, v56
    v_add_f32 v29, v29, v57
    v_add_f32 v30, v30, v58
    v_add_f32 v31, v31, v59
    v_add_f32 v28, v28, v60
    v_add_f32 v29, v29, v61
    v_add_f32 v30, v30, v62
    v_add_f32 v31, v31, v63
    v_add_f32 v28, v28, v29
    v_add_f32 v30, v30, v31
    v_add_f32 v28, v28, v30
    s_waitcnt vmcnt(5)
    buffer_load_dwordx4 v[176:179], v5, s[52:55], s61 offen offset:0 nt
    v_add_f32_dpp v28, v28, v28 row_ror:4 row_mask:0xf bank_mask:0xf
    s_nop 1
    v_add_f32_dpp v28, v28, v28 row_ror:8 row_mask:0xf bank_mask:0xf
    v_mov_b32 v29, v28
    s_nop 1
    v_permlane16_swap_b32 v28, v29
    v_add_f32 v28, v28, v29
    v_mov_b32 v29, v28
    s_nop 1
    v_permlane32_swap_b32 v28, v29
    v_add_f32 v28, v28, v29
    v_mov_b32 v1, 0x264c0
    v_mov_b32 v2, 1
    s_mov_b64 exec, 15
    ds_write_b32 v47, v44
    ds_write_b32 v47, v28 offset:64
    s_mov_b64 exec, 1
    ds_add_u32 v1, v2 offset:8
    s_mov_b64 exec, -1
    v_cvt_pk_bf16_f32 v48, v48, v49
    v_cvt_pk_bf16_f32 v49, v50, v51
    v_cvt_pk_bf16_f32 v50, v52, v53
    v_cvt_pk_bf16_f32 v51, v54, v55
    v_cvt_pk_bf16_f32 v52, v56, v57
    v_cvt_pk_bf16_f32 v53, v58, v59
    v_cvt_pk_bf16_f32 v54, v60, v61
    v_cvt_pk_bf16_f32 v55, v62, v63
    s_waitcnt lgkmcnt(0)
    s_waitcnt vmcnt(5)
    buffer_load_dwordx4 v[180:183], v5, s[52:55], s61 offen offset:1024 nt
    v_perm_b32 v56, v68, v64, s8
    v_perm_b32 v57, v76, v72, s8
    v_perm_b32 v58, v84, v80, s8
    v_perm_b32 v59, v92, v88, s8
    v_perm_b32 v60, v68, v64, s9
    v_perm_b32 v61, v76, v72, s9
    v_perm_b32 v62, v84, v80, s9
    v_perm_b32 v63, v92, v88, s9
    v_mfma_f32_16x16x32_bf16 v[12:15], v[48:51], v[56:59], 0
    s_nop 0
    v_mfma_f32_16x16x32_bf16 v[16:19], v[48:51], v[60:63], 0
    s_waitcnt vmcnt(5)
    buffer_load_dwordx4 v[184:187], v5, s[52:55], s61 offen offset:2048 nt
    v_perm_b32 v56, v69, v65, s8
    v_perm_b32 v57, v77, v73, s8
    v_perm_b32 v58, v85, v81, s8
    v_perm_b32 v59, v93, v89, s8
    v_perm_b32 v60, v69, v65, s9
    v_perm_b32 v61, v77, v73, s9
    v_perm_b32 v62, v85, v81, s9
    v_perm_b32 v63, v93, v89, s9
    v_mfma_f32_16x16x32_bf16 v[20:23], v[48:51], v[56:59], 0
    s_nop 0
    v_mfma_f32_16x16x32_bf16 v[24:27], v[48:51], v[60:63], 0
    s_waitcnt vmcnt(5)
    buffer_load_dwordx4 v[188:191], v5, s[52:55], s61 offen offset:3072 nt
    s_add_u32 s61, s12, 131072
    v_perm_b32 v56, v70, v66, s8
    v_perm_b32 v57, v78, v74, s8
    v_perm_b32 v58, v86, v82, s8
    v_perm_b32 v59, v94, v90, s8
    v_perm_b32 v60, v70, v66, s9
    v_perm_b32 v61, v78, v74, s9
    v_perm_b32 v62, v86, v82, s9
    v_perm_b32 v63, v94, v90, s9
    v_mfma_f32_16x16x32_bf16 v[28:31], v[48:51], v[56:59], 0
    s_nop 0
    v_mfma_f32_16x16x32_bf16 v[32:35], v[48:51], v[60:63], 0
    s_waitcnt vmcnt(5)
    buffer_load_dwordx4 v[192:195], v5, s[52:55], s61 offen offset:0 nt
    v_perm_b32 v56, v71, v67, s8
    v_perm_b32 v57, v79, v75, s8
    v_perm_b32 v58, v87, v83, s8
    v_perm_b32 v59, v95, v91, s8
    v_perm_b32 v60, v71, v67, s9
    v_perm_b32 v61, v79, v75, s9
    v_perm_b32 v62, v87, v83, s9
    v_perm_b32 v63, v95, v91, s9
    v_mfma_f32_16x16x32_bf16 v[36:39], v[48:51], v[56:59], 0
    s_nop 0
    v_mfma_f32_16x16x32_bf16 v[40:43], v[48:51], v[60:63], 0
    s_waitcnt vmcnt(5)
    buffer_load_dwordx4 v[196:199], v5, s[52:55], s61 offen offset:1024 nt
    v_mov_b32_dpp v44, v48 row_shl:4 row_mask:0xf bank_mask:0xf bound_ctrl:0
    v_mov_b32_dpp v45, v49 row_shl:4 row_mask:0xf bank_mask:0xf bound_ctrl:0
    v_mov_b32_dpp v46, v50 row_shl:4 row_mask:0xf bank_mask:0xf bound_ctrl:0
    v_mov_b32_dpp v47, v51 row_shl:4 row_mask:0xf bank_mask:0xf bound_ctrl:0
    v_perm_b32 v56, v100, v96, s8
    v_perm_b32 v57, v108, v104, s8
    v_perm_b32 v58, v116, v112, s8
    v_perm_b32 v59, v124, v120, s8
    v_perm_b32 v60, v100, v96, s9
    v_perm_b32 v61, v108, v104, s9
    v_perm_b32 v62, v116, v112, s9
    v_perm_b32 v63, v124, v120, s9
    v_mfma_f32_16x16x32_bf16 v[12:15], v[44:47], v[56:59], v[12:15]
    s_nop 0
    v_mfma_f32_16x16x32_bf16 v[16:19], v[44:47], v[60:63], v[16:19]
    s_waitcnt vmcnt(5)
    buffer_load_dwordx4 v[200:203], v5, s[52:55], s61 offen offset:2048 nt
    v_perm_b32 v56, v101, v97, s8
    v_perm_b32 v57, v109, v105, s8
    v_perm_b32 v58, v117, v113, s8
    v_perm_b32 v59, v125, v121, s8
    v_perm_b32 v60, v101, v97, s9
    v_perm_b32 v61, v109, v105, s9
    v_perm_b32 v62, v117, v113, s9
    v_perm_b32 v63, v125, v121, s9
    v_mfma_f32_16x16x32_bf16 v[20:23], v[44:47], v[56:59], v[20:23]
    s_nop 0
    v_mfma_f32_16x16x32_bf16 v[24:27], v[44:47], v[60:63], v[24:27]
    s_waitcnt vmcnt(5)
    buffer_load_dwordx4 v[204:207], v5, s[52:55], s61 offen offset:3072 nt
    s_add_u32 s61, s13, 147456
    v_perm_b32 v56, v102, v98, s8
    v_perm_b32 v57, v110, v106, s8
    v_perm_b32 v58, v118, v114, s8
    v_perm_b32 v59, v126, v122, s8
    v_perm_b32 v60, v102, v98, s9
    v_perm_b32 v61, v110, v106, s9
    v_perm_b32 v62, v118, v114, s9
    v_perm_b32 v63, v126, v122, s9
    v_mfma_f32_16x16x32_bf16 v[28:31], v[44:47], v[56:59], v[28:31]
    s_nop 0
    v_mfma_f32_16x16x32_bf16 v[32:35], v[44:47], v[60:63], v[32:35]
    s_waitcnt vmcnt(5)
    buffer_load_dwordx4 v[208:211], v5, s[52:55], s61 offen offset:0 nt
    v_perm_b32 v56, v103, v99, s8
    v_perm_b32 v57, v111, v107, s8
    v_perm_b32 v58, v119, v115, s8
    v_perm_b32 v59, v127, v123, s8
    v_perm_b32 v60, v103, v99, s9
    v_perm_b32 v61, v111, v107, s9
    v_perm_b32 v62, v119, v115, s9
    v_perm_b32 v63, v127, v123, s9
    v_mfma_f32_16x16x32_bf16 v[36:39], v[44:47], v[56:59], v[36:39]
    s_nop 0
    v_mfma_f32_16x16x32_bf16 v[40:43], v[44:47], v[60:63], v[40:43]
    s_waitcnt vmcnt(5)
    buffer_load_dwordx4 v[212:215], v5, s[52:55], s61 offen offset:1024 nt
    v_mov_b32_dpp v44, v48 row_shl:8 row_mask:0xf bank_mask:0xf bound_ctrl:0
    v_mov_b32_dpp v45, v49 row_shl:8 row_mask:0xf bank_mask:0xf bound_ctrl:0
    v_mov_b32_dpp v46, v50 row_shl:8 row_mask:0xf bank_mask:0xf bound_ctrl:0
    v_mov_b32_dpp v47, v51 row_shl:8 row_mask:0xf bank_mask:0xf bound_ctrl:0
    v_perm_b32 v56, v132, v128, s8
    v_perm_b32 v57, v140, v136, s8
    v_perm_b32 v58, v148, v144, s8
    v_perm_b32 v59, v156, v152, s8
    v_perm_b32 v60, v132, v128, s9
    v_perm_b32 v61, v140, v136, s9
    v_perm_b32 v62, v148, v144, s9
    v_perm_b32 v63, v156, v152, s9
    v_mfma_f32_16x16x32_bf16 v[12:15], v[44:47], v[56:59], v[12:15]
    s_nop 0
    v_mfma_f32_16x16x32_bf16 v[16:19], v[44:47], v[60:63], v[16:19]
    s_waitcnt vmcnt(5)
    buffer_load_dwordx4 v[216:219], v5, s[52:55], s61 offen offset:2048 nt
    v_perm_b32 v56, v133, v129, s8
    v_perm_b32 v57, v141, v137, s8
    v_perm_b32 v58, v149, v145, s8
    v_perm_b32 v59, v157, v153, s8
    v_perm_b32 v60, v133, v129, s9
    v_perm_b32 v61, v141, v137, s9
    v_perm_b32 v62, v149, v145, s9
    v_perm_b32 v63, v157, v153, s9
    v_mfma_f32_16x16x32_bf16 v[20:23], v[44:47], v[56:59], v[20:23]
    s_nop 0
    v_mfma_f32_16x16x32_bf16 v[24:27], v[44:47], v[60:63], v[24:27]
    s_waitcnt vmcnt(5)
    buffer_load_dwordx4 v[220:223], v5, s[52:55], s61 offen offset:3072 nt
    s_add_u32 s61, s14, 163840
    v_perm_b32 v56, v134, v130, s8
    v_perm_b32 v57, v142, v138, s8
    v_perm_b32 v58, v150, v146, s8
    v_perm_b32 v59, v158, v154, s8
    v_perm_b32 v60, v134, v130, s9
    v_perm_b32 v61, v142, v138, s9
    v_perm_b32 v62, v150, v146, s9
    v_perm_b32 v63, v158, v154, s9
    v_mfma_f32_16x16x32_bf16 v[28:31], v[44:47], v[56:59], v[28:31]
    s_nop 0
    v_mfma_f32_16x16x32_bf16 v[32:35], v[44:47], v[60:63], v[32:35]
    s_waitcnt vmcnt(5)
    buffer_load_dwordx4 v[224:227], v5, s[52:55], s61 offen offset:0 nt
    v_perm_b32 v56, v135, v131, s8
    v_perm_b32 v57, v143, v139, s8
    v_perm_b32 v58, v151, v147, s8
    v_perm_b32 v59, v159, v155, s8
    v_perm_b32 v60, v135, v131, s9
    v_perm_b32 v61, v143, v139, s9
    v_perm_b32 v62, v151, v147, s9
    v_perm_b32 v63, v159, v155, s9
    v_mfma_f32_16x16x32_bf16 v[36:39], v[44:47], v[56:59], v[36:39]
    s_nop 0
    v_mfma_f32_16x16x32_bf16 v[40:43], v[44:47], v[60:63], v[40:43]
    s_waitcnt vmcnt(5)
    buffer_load_dwordx4 v[228:231], v5, s[52:55], s61 offen offset:1024 nt
    v_mov_b32_dpp v44, v48 row_shl:12 row_mask:0xf bank_mask:0xf bound_ctrl:0
    v_mov_b32_dpp v45, v49 row_shl:12 row_mask:0xf bank_mask:0xf bound_ctrl:0
    v_mov_b32_dpp v46, v50 row_shl:12 row_mask:0xf bank_mask:0xf bound_ctrl:0
    v_mov_b32_dpp v47, v51 row_shl:12 row_mask:0xf bank_mask:0xf bound_ctrl:0
    v_perm_b32 v56, v164, v160, s8
    v_perm_b32 v57, v172, v168, s8
    v_perm_b32 v58, v180, v176, s8
    v_perm_b32 v59, v188, v184, s8
    v_perm_b32 v60, v164, v160, s9
    v_perm_b32 v61, v172, v168, s9
    v_perm_b32 v62, v180, v176, s9
    v_perm_b32 v63, v188, v184, s9
    v_mfma_f32_16x16x32_bf16 v[12:15], v[44:47], v[56:59], v[12:15]
    s_nop 0
    v_mfma_f32_16x16x32_bf16 v[16:19], v[44:47], v[60:63], v[16:19]
    s_waitcnt vmcnt(5)
    buffer_load_dwordx4 v[232:235], v5, s[52:55], s61 offen offset:2048 nt
    v_perm_b32 v56, v165, v161, s8
    v_perm_b32 v57, v173, v169, s8
    v_perm_b32 v58, v181, v177, s8
    v_perm_b32 v59, v189, v185, s8
    v_perm_b32 v60, v165, v161, s9
    v_perm_b32 v61, v173, v169, s9
    v_perm_b32 v62, v181, v177, s9
    v_perm_b32 v63, v189, v185, s9
    v_mfma_f32_16x16x32_bf16 v[20:23], v[44:47], v[56:59], v[20:23]
    s_nop 0
    v_mfma_f32_16x16x32_bf16 v[24:27], v[44:47], v[60:63], v[24:27]
    s_waitcnt vmcnt(5)
    buffer_load_dwordx4 v[236:239], v5, s[52:55], s61 offen offset:3072 nt
    s_add_u32 s61, s15, 180224
    v_perm_b32 v56, v166, v162, s8
    v_perm_b32 v57, v174, v170, s8
    v_perm_b32 v58, v182, v178, s8
    v_perm_b32 v59, v190, v186, s8
    v_perm_b32 v60, v166, v162, s9
    v_perm_b32 v61, v174, v170, s9
    v_perm_b32 v62, v182, v178, s9
    v_perm_b32 v63, v190, v186, s9
    v_mfma_f32_16x16x32_bf16 v[28:31], v[44:47], v[56:59], v[28:31]
    s_nop 0
    v_mfma_f32_16x16x32_bf16 v[32:35], v[44:47], v[60:63], v[32:35]
    s_waitcnt vmcnt(5)
    buffer_load_dwordx4 v[240:243], v5, s[52:55], s61 offen offset:0 nt
    v_perm_b32 v56, v167, v163, s8
    v_perm_b32 v57, v175, v171, s8
    v_perm_b32 v58, v183, v179, s8
    v_perm_b32 v59, v191, v187, s8
    v_perm_b32 v60, v167, v163, s9
    v_perm_b32 v61, v175, v171, s9
    v_perm_b32 v62, v183, v179, s9
    v_perm_b32 v63, v191, v187, s9
    v_mfma_f32_16x16x32_bf16 v[36:39], v[44:47], v[56:59], v[36:39]
    s_nop 0
    v_mfma_f32_16x16x32_bf16 v[40:43], v[44:47], v[60:63], v[40:43]
    s_waitcnt vmcnt(5)
    buffer_load_dwordx4 v[244:247], v5, s[52:55], s61 offen offset:1024 nt
    v_perm_b32 v56, v196, v192, s8
    v_perm_b32 v57, v204, v200, s8
    v_perm_b32 v58, v212, v208, s8
    v_perm_b32 v59, v220, v216, s8
    v_perm_b32 v60, v196, v192, s9
    v_perm_b32 v61, v204, v200, s9
    v_perm_b32 v62, v212, v208, s9
    v_perm_b32 v63, v220, v216, s9
    v_mfma_f32_16x16x32_bf16 v[12:15], v[52:55], v[56:59], v[12:15]
    s_nop 0
    v_mfma_f32_16x16x32_bf16 v[16:19], v[52:55], v[60:63], v[16:19]
    s_waitcnt vmcnt(5)
    buffer_load_dwordx4 v[248:251], v5, s[52:55], s61 offen offset:2048 nt
    v_perm_b32 v56, v197, v193, s8
    v_perm_b32 v57, v205, v201, s8
    v_perm_b32 v58, v213, v209, s8
    v_perm_b32 v59, v221, v217, s8
    v_perm_b32 v60, v197, v193, s9
    v_perm_b32 v61, v205, v201, s9
    v_perm_b32 v62, v213, v209, s9
    v_perm_b32 v63, v221, v217, s9
    v_mfma_f32_16x16x32_bf16 v[20:23], v[52:55], v[56:59], v[20:23]
    s_nop 0
    v_mfma_f32_16x16x32_bf16 v[24:27], v[52:55], v[60:63], v[24:27]
    s_waitcnt vmcnt(5)
    buffer_load_dwordx4 v[252:255], v5, s[52:55], s61 offen offset:3072 nt
    s_add_u32 s61, s12, 196608
    v_perm_b32 v56, v198, v194, s8
    v_perm_b32 v57, v206, v202, s8
    v_perm_b32 v58, v214, v210, s8
    v_perm_b32 v59, v222, v218, s8
    v_perm_b32 v60, v198, v194, s9
    v_perm_b32 v61, v206, v202, s9
    v_perm_b32 v62, v214, v210, s9
    v_perm_b32 v63, v222, v218, s9
    v_mfma_f32_16x16x32_bf16 v[28:31], v[52:55], v[56:59], v[28:31]
    s_nop 0
    v_mfma_f32_16x16x32_bf16 v[32:35], v[52:55], v[60:63], v[32:35]
    s_waitcnt vmcnt(5)
    buffer_load_dwordx4 v[64:67], v5, s[52:55], s61 offen offset:0 nt
    v_perm_b32 v56, v199, v195, s8
    v_perm_b32 v57, v207, v203, s8
    v_perm_b32 v58, v215, v211, s8
    v_perm_b32 v59, v223, v219, s8
    v_perm_b32 v60, v199, v195, s9
    v_perm_b32 v61, v207, v203, s9
    v_perm_b32 v62, v215, v211, s9
    v_perm_b32 v63, v223, v219, s9
    v_mfma_f32_16x16x32_bf16 v[36:39], v[52:55], v[56:59], v[36:39]
    s_nop 0
    v_mfma_f32_16x16x32_bf16 v[40:43], v[52:55], v[60:63], v[40:43]
    s_waitcnt vmcnt(5)
    buffer_load_dwordx4 v[68:71], v5, s[52:55], s61 offen offset:1024 nt
    s_waitcnt vmcnt(5)
    buffer_load_dwordx4 v[72:75], v5, s[52:55], s61 offen offset:2048 nt
    s_waitcnt vmcnt(5)
    buffer_load_dwordx4 v[76:79], v5, s[52:55], s61 offen offset:3072 nt
    s_add_u32 s61, s13, 212992
    s_waitcnt vmcnt(5)
    buffer_load_dwordx4 v[80:83], v5, s[52:55], s61 offen offset:0 nt
    s_waitcnt vmcnt(5)
    buffer_load_dwordx4 v[84:87], v5, s[52:55], s61 offen offset:1024 nt
    v_mov_b32_dpp v44, v52 row_shl:4 row_mask:0xf bank_mask:0xf bound_ctrl:0
    v_mov_b32_dpp v45, v53 row_shl:4 row_mask:0xf bank_mask:0xf bound_ctrl:0
    v_mov_b32_dpp v46, v54 row_shl:4 row_mask:0xf bank_mask:0xf bound_ctrl:0
    v_mov_b32_dpp v47, v55 row_shl:4 row_mask:0xf bank_mask:0xf bound_ctrl:0
    v_perm_b32 v56, v228, v224, s8
    v_perm_b32 v57, v236, v232, s8
    v_perm_b32 v58, v244, v240, s8
    v_perm_b32 v59, v252, v248, s8
    v_perm_b32 v60, v228, v224, s9
    v_perm_b32 v61, v236, v232, s9
    v_perm_b32 v62, v244, v240, s9
    v_perm_b32 v63, v252, v248, s9
    v_mfma_f32_16x16x32_bf16 v[12:15], v[44:47], v[56:59], v[12:15]
    s_nop 0
    v_mfma_f32_16x16x32_bf16 v[16:19], v[44:47], v[60:63], v[16:19]
    s_waitcnt vmcnt(5)
    buffer_load_dwordx4 v[88:91], v5, s[52:55], s61 offen offset:2048 nt
    v_perm_b32 v56, v229, v225, s8
    v_perm_b32 v57, v237, v233, s8
    v_perm_b32 v58, v245, v241, s8
    v_perm_b32 v59, v253, v249, s8
    v_perm_b32 v60, v229, v225, s9
    v_perm_b32 v61, v237, v233, s9
    v_perm_b32 v62, v245, v241, s9
    v_perm_b32 v63, v253, v249, s9
    v_mfma_f32_16x16x32_bf16 v[20:23], v[44:47], v[56:59], v[20:23]
    s_nop 0
    v_mfma_f32_16x16x32_bf16 v[24:27], v[44:47], v[60:63], v[24:27]
    s_waitcnt vmcnt(5)
    buffer_load_dwordx4 v[92:95], v5, s[52:55], s61 offen offset:3072 nt
    s_add_u32 s61, s14, 229376
    v_perm_b32 v56, v230, v226, s8
    v_perm_b32 v57, v238, v234, s8
    v_perm_b32 v58, v246, v242, s8
    v_perm_b32 v59, v254, v250, s8
    v_perm_b32 v60, v230, v226, s9
    v_perm_b32 v61, v238, v234, s9
    v_perm_b32 v62, v246, v242, s9
    v_perm_b32 v63, v254, v250, s9
    v_mfma_f32_16x16x32_bf16 v[28:31], v[44:47], v[56:59], v[28:31]
    s_nop 0
    v_mfma_f32_16x16x32_bf16 v[32:35], v[44:47], v[60:63], v[32:35]
    s_waitcnt vmcnt(5)
    buffer_load_dwordx4 v[96:99], v5, s[52:55], s61 offen offset:0 nt
    v_perm_b32 v56, v231, v227, s8
    v_perm_b32 v57, v239, v235, s8
    v_perm_b32 v58, v247, v243, s8
    v_perm_b32 v59, v255, v251, s8
    v_perm_b32 v60, v231, v227, s9
    v_perm_b32 v61, v239, v235, s9
    v_perm_b32 v62, v247, v243, s9
    v_perm_b32 v63, v255, v251, s9
    v_mfma_f32_16x16x32_bf16 v[36:39], v[44:47], v[56:59], v[36:39]
    s_nop 0
    v_mfma_f32_16x16x32_bf16 v[40:43], v[44:47], v[60:63], v[40:43]
    s_waitcnt vmcnt(5)
    buffer_load_dwordx4 v[100:103], v5, s[52:55], s61 offen offset:1024 nt
    s_waitcnt vmcnt(5)
    buffer_load_dwordx4 v[104:107], v5, s[52:55], s61 offen offset:2048 nt
    s_waitcnt vmcnt(5)
    buffer_load_dwordx4 v[108:111], v5, s[52:55], s61 offen offset:3072 nt
    s_add_u32 s61, s15, 245760
    s_waitcnt vmcnt(5)
    buffer_load_dwordx4 v[112:115], v5, s[52:55], s61 offen offset:0 nt
    s_waitcnt vmcnt(5)
    buffer_load_dwordx4 v[116:119], v5, s[52:55], s61 offen offset:1024 nt
    v_mov_b32_dpp v44, v52 row_shl:8 row_mask:0xf bank_mask:0xf bound_ctrl:0
    v_mov_b32_dpp v45, v53 row_shl:8 row_mask:0xf bank_mask:0xf bound_ctrl:0
    v_mov_b32_dpp v46, v54 row_shl:8 row_mask:0xf bank_mask:0xf bound_ctrl:0
    v_mov_b32_dpp v47, v55 row_shl:8 row_mask:0xf bank_mask:0xf bound_ctrl:0
    v_perm_b32 v56, v68, v64, s8
    v_perm_b32 v57, v76, v72, s8
    v_perm_b32 v58, v84, v80, s8
    v_perm_b32 v59, v92, v88, s8
    v_perm_b32 v60, v68, v64, s9
    v_perm_b32 v61, v76, v72, s9
    v_perm_b32 v62, v84, v80, s9
    v_perm_b32 v63, v92, v88, s9
    v_mfma_f32_16x16x32_bf16 v[12:15], v[44:47], v[56:59], v[12:15]
    s_nop 0
    v_mfma_f32_16x16x32_bf16 v[16:19], v[44:47], v[60:63], v[16:19]
    s_waitcnt vmcnt(5)
    buffer_load_dwordx4 v[120:123], v5, s[52:55], s61 offen offset:2048 nt
    v_perm_b32 v56, v69, v65, s8
    v_perm_b32 v57, v77, v73, s8
    v_perm_b32 v58, v85, v81, s8
    v_perm_b32 v59, v93, v89, s8
    v_perm_b32 v60, v69, v65, s9
    v_perm_b32 v61, v77, v73, s9
    v_perm_b32 v62, v85, v81, s9
    v_perm_b32 v63, v93, v89, s9
    v_mfma_f32_16x16x32_bf16 v[20:23], v[44:47], v[56:59], v[20:23]
    s_nop 0
    v_mfma_f32_16x16x32_bf16 v[24:27], v[44:47], v[60:63], v[24:27]
    s_waitcnt vmcnt(5)
    buffer_load_dwordx4 v[124:127], v5, s[52:55], s61 offen offset:3072 nt
    v_mov_b32 v1, 0x264c0
    v_mov_b32 v2, 1
    s_mov_b64 exec, 1
    ds_add_u32 v1, v2 offset:12
    s_mov_b64 exec, -1
    v_perm_b32 v56, v70, v66, s8
    v_perm_b32 v57, v78, v74, s8
    v_perm_b32 v58, v86, v82, s8
    v_perm_b32 v59, v94, v90, s8
    v_perm_b32 v60, v70, v66, s9
    v_perm_b32 v61, v78, v74, s9
    v_perm_b32 v62, v86, v82, s9
    v_perm_b32 v63, v94, v90, s9
    v_mfma_f32_16x16x32_bf16 v[28:31], v[44:47], v[56:59], v[28:31]
    s_nop 0
    v_mfma_f32_16x16x32_bf16 v[32:35], v[44:47], v[60:63], v[32:35]
    v_perm_b32 v56, v71, v67, s8
    v_perm_b32 v57, v79, v75, s8
    v_perm_b32 v58, v87, v83, s8
    v_perm_b32 v59, v95, v91, s8
    v_perm_b32 v60, v71, v67, s9
    v_perm_b32 v61, v79, v75, s9
    v_perm_b32 v62, v87, v83, s9
    v_perm_b32 v63, v95, v91, s9
    v_mfma_f32_16x16x32_bf16 v[36:39], v[44:47], v[56:59], v[36:39]
    s_nop 0
    v_mfma_f32_16x16x32_bf16 v[40:43], v[44:47], v[60:63], v[40:43]
    v_mov_b32 v1, 0x264c0
    s_mov_b32 s63, 1600000
L_wml:
    ds_read_b32 v2, v1 offset:8
    s_waitcnt lgkmcnt(0)
    v_cmp_gt_u32 vcc, 6, v2
    s_nop 0
    s_cbranch_vccz L_wml_go
    s_sub_u32 s63, s63, 1
    s_cbranch_scc0 L_wml
L_wml_go:
    s_lshl_b32 s6, s3, 4
    s_add_u32 s6, s6, 0x26400
    v_lshrrev_b32 v3, 5, v0
    v_lshl_add_u32 v1, v3, 3, s6
    ds_read_b64 v[6:7], v1
    s_lshl_b32 s6, s3, 2
    s_add_u32 s7, s6, 0x26490
    v_mov_b32 v1, s7
    ds_read_b32 v8, v1
    v_mov_b32 v1, 0x26480
    ds_read_b32 v4, v1
    ds_read_b32 v9, v1 offset:88
    v_and_b32 v2, 1, v0
    v_lshlrev_b32 v2, 10, v2
    v_lshl_add_u32 v2, v3, 16, v2
    v_bfe_u32 v3, v0, 1, 4
    v_lshl_add_u32 v2, v3, 4, v2
    v_add_u32 v2, s6, v2
    v_add_u32 v3, s62, v5
    s_waitcnt lgkmcnt(0)
    v_readfirstlane_b32 s92, v9
    v_sub_f32 v6, v6, v8
    v_sub_f32 v7, v7, v8
    v_exp_f32 v6, v6
    v_exp_f32 v7, v7
    v_sub_f32 v9, 1.0, v4
    v_mul_f32 v6, v6, v4
    v_mul_f32 v7, v7, v4
    v_lshlrev_b32 v10, 16, v10
    v_lshlrev_b32 v11, 16, v11
    v_mul_f32 v10, v10, v9
    v_mul_f32 v11, v11, v9
    s_and_b32 s6, s11, 0x1c
    s_add_u32 s6, s6, s3
    s_lshl_b32 s63, s6, 14
    s_lshr_b32 s6, s11, 5
    s_lshl_b32 s6, s6, 11
    s_add_u32 s63, s63, s6
    s_and_b32 s6, s11, 3
    s_lshl_b32 s6, s6, 9
    s_add_u32 s63, s63, s6
    s_add_u32 s63, s63, 0x200000
    v_mov_b32 v1, 0x264c0
    v_mov_b32 v4, 1
    v_mov_b32_dpp v44, v52 row_shl:12 row_mask:0xf bank_mask:0xf bound_ctrl:0
    v_mov_b32_dpp v45, v53 row_shl:12 row_mask:0xf bank_mask:0xf bound_ctrl:0
    v_mov_b32_dpp v46, v54 row_shl:12 row_mask:0xf bank_mask:0xf bound_ctrl:0
    v_mov_b32_dpp v47, v55 row_shl:12 row_mask:0xf bank_mask:0xf bound_ctrl:0
    v_perm_b32 v128, v100, v96, s8
    v_perm_b32 v132, v100, v96, s9
    v_perm_b32 v136, v101, v97, s8
    v_perm_b32 v140, v101, v97, s9
    v_perm_b32 v144, v102, v98, s8
    v_perm_b32 v148, v102, v98, s9
    v_perm_b32 v152, v103, v99, s8
    v_perm_b32 v156, v103, v99, s9
    s_waitcnt vmcnt(4)
    v_perm_b32 v129, v108, v104, s8
    v_perm_b32 v133, v108, v104, s9
    v_perm_b32 v137, v109, v105, s8
    v_perm_b32 v141, v109, v105, s9
    v_perm_b32 v145, v110, v106, s8
    v_perm_b32 v149, v110, v106, s9
    v_perm_b32 v153, v111, v107, s8
    v_perm_b32 v157, v111, v107, s9
    s_waitcnt vmcnt(2)
    v_perm_b32 v130, v116, v112, s8
    v_perm_b32 v134, v116, v112, s9
    v_perm_b32 v138, v117, v113, s8
    v_perm_b32 v142, v117, v113, s9
    v_perm_b32 v146, v118, v114, s8
    v_perm_b32 v150, v118, v114, s9
    v_perm_b32 v154, v119, v115, s8
    v_perm_b32 v158, v119, v115, s9
    s_waitcnt vmcnt(0)
    v_perm_b32 v131, v124, v120, s8
    v_perm_b32 v135, v124, v120, s9
    v_perm_b32 v139, v125, v121, s8
    v_perm_b32 v143, v125, v121, s9
    v_perm_b32 v147, v126, v122, s8
    v_perm_b32 v151, v126, v122, s9
    v_perm_b32 v155, v127, v123, s8
    v_perm_b32 v159, v127, v123, s9
    v_mfma_f32_16x16x32_bf16 v[12:15], v[44:47], v[128:131], v[12:15]
    v_mfma_f32_16x16x32_bf16 v[16:19], v[44:47], v[132:135], v[16:19]
    v_mfma_f32_16x16x32_bf16 v[20:23], v[44:47], v[136:139], v[20:23]
    v_mfma_f32_16x16x32_bf16 v[24:27], v[44:47], v[140:143], v[24:27]
    v_mfma_f32_16x16x32_bf16 v[28:31], v[44:47], v[144:147], v[28:31]
    v_mfma_f32_16x16x32_bf16 v[32:35], v[44:47], v[148:151], v[32:35]
    v_mfma_f32_16x16x32_bf16 v[36:39], v[44:47], v[152:155], v[36:39]
    v_mfma_f32_16x16x32_bf16 v[40:43], v[44:47], v[156:159], v[40:43]
    s_mov_b64 exec, 0xffff
    ds_write_b128 v3, v[12:15] offset:0
    ds_write_b128 v3, v[16:19] offset:256
    ds_write_b128 v3, v[20:23] offset:512
    ds_write_b128 v3, v[24:27] offset:768
    ds_write_b128 v3, v[28:31] offset:1024
    ds_write_b128 v3, v[32:35] offset:1280
    ds_write_b128 v3, v[36:39] offset:1536
    ds_write_b128 v3, v[40:43] offset:1792
    s_mov_b64 exec, 1
    ds_add_u32 v1, v4 offset:20
    s_mov_b64 exec, -1
    v_mov_b32 v49, s5
    v_mov_b32 v51, s5
    s_mov_b32 s60, 1600000
    s_setprio 0
    s_branch L_wo
L_wo_s:
    s_sleep 1
L_wo:
    ds_read_b32 v44, v1 offset:20
    ds_read2st64_b32 v[52:53], v2 offset0:0 offset1:1
    ds_read2st64_b32 v[54:55], v2 offset0:2 offset1:3
    ds_read2st64_b32 v[56:57], v2 offset0:128 offset1:129
    ds_read2st64_b32 v[58:59], v2 offset0:130 offset1:131
    s_waitcnt lgkmcnt(4)
    v_cmp_gt_u32 vcc, 4, v44
    s_sub_u32 s60, s60, 1
    s_cbranch_scc1 L_wo_go
    s_cbranch_vccnz L_wo_s
L_wo_go:
    s_setprio 3
    s_waitcnt lgkmcnt(2)
    v_mul_f32 v52, v52, v6
    v_mul_f32 v53, v53, v6
    v_mul_f32 v54, v54, v6
    v_mul_f32 v55, v55, v6
    s_waitcnt lgkmcnt(0)
    v_fma_f32 v52, v56, v7, v52
    v_fma_f32 v53, v57, v7, v53
    v_fma_f32 v54, v58, v7, v54
    v_fma_f32 v55, v59, v7, v55
    v_mov_b32 v56, v52
    v_mov_b32 v57, v53
    v_mov_b32 v58, v54
    v_mov_b32 v59, v55
    v_permlane32_swap_b32 v52, v56
    v_permlane32_swap_b32 v53, v57
    v_permlane32_swap_b32 v54, v58
    v_permlane32_swap_b32 v55, v59
    v_add_f32 v52, v52, v56
    v_add_f32 v53, v53, v57
    v_add_f32 v54, v54, v58
    v_add_f32 v55, v55, v59
    v_cvt_pk_bf16_f32 v48, v52, v53
    v_cvt_pk_bf16_f32 v50, v54, v55
    s_mov_b64 exec, 0xffffffff
    s_cmp_lg_u32 s92, 0
    s_cbranch_scc1 L_o_slow
    buffer_store_dwordx4 v[48:51], v5, s[44:47], s63 offen
L_o_done:
    s_setprio 0
    s_mov_b64 exec, -1
    s_cmp_lg_u32 s3, 0
    s_cbranch_scc1 L_end
    s_mov_b32 s48, s38
    s_mov_b32 s49, s39
    s_mov_b32 s50, 0x2000
    s_mov_b32 s51, 0x00020000
    s_lshr_b32 s6, s11, 5
    s_lshl_b32 s60, s11, 12
    s_add_u32 s60, s60, 0x280000
    s_lshl_b32 s6, s6, 9
    s_add_u32 s6, s6, s69
    s_lshl_b32 s61, s6, 1
    v_lshlrev_b32 v2, 1, v0
    s_mov_b32 s62, 400000
L_fin_poll:
    buffer_load_dwordx4 v[12:15], v5, s[44:47], s60 offen offset:0 sc1
    buffer_load_dwordx4 v[16:19], v5, s[44:47], s60 offen offset:1024 sc1
    buffer_load_dwordx4 v[20:23], v5, s[44:47], s60 offen offset:2048 sc1
    buffer_load_dwordx4 v[24:27], v5, s[44:47], s60 offen offset:3072 sc1
    s_waitcnt vmcnt(2)
    v_xor_b32 v28, s5, v13
    v_xor_b32 v29, s5, v15
    v_xor_b32 v30, s5, v17
    v_xor_b32 v31, s5, v19
    v_add_f32 v12, v12, v16
    v_add_f32 v14, v14, v18
    v_or3_b32 v28, v28, v29, v30
    s_waitcnt vmcnt(0)
    v_xor_b32 v29, s5, v21
    v_xor_b32 v30, s5, v23
    v_xor_b32 v32, s5, v25
    v_xor_b32 v33, s5, v27
    v_add_f32 v20, v20, v24
    v_add_f32 v22, v22, v26
    v_or3_b32 v28, v28, v31, v29
    v_or3_b32 v30, v30, v32, v33
    v_add_f32 v12, v12, v20
    v_add_f32 v14, v14, v22
    v_or_b32 v28, v28, v30
    v_cmp_ne_u32 vcc, 0, v28
    s_sub_u32 s62, s62, 1
    s_cbranch_scc1 L_fin_go
    s_cbranch_vccnz L_fin_poll
L_fin_go:
    v_add_f32_dpp v12, v12, v12 row_ror:8 row_mask:0xf bank_mask:0xf
    v_add_f32_dpp v14, v14, v14 row_ror:8 row_mask:0xf bank_mask:0xf
    v_mov_b32 v13, v12
    v_mov_b32 v15, v14
    s_nop 0
    v_permlane16_swap_b32 v12, v13
    v_permlane16_swap_b32 v14, v15
    v_add_f32 v12, v12, v13
    v_add_f32 v14, v14, v15
    v_mov_b32 v13, v12
    v_mov_b32 v15, v14
    s_nop 0
    v_permlane32_swap_b32 v12, v13
    v_permlane32_swap_b32 v14, v15
    v_add_f32 v12, v12, v13
    v_add_f32 v14, v14, v15
    v_add_f32 v12, v12, v10
    v_add_f32 v14, v14, v11
    v_cvt_pk_bf16_f32 v12, v12, v14
    s_mov_b64 exec, 0xff
    buffer_store_short v12, v2, s[48:51], s61 offen
    buffer_store_short_d16_hi v12, v2, s[48:51], s61 offen offset:32
    s_cmp_lg_u32 s2, 0
    s_cbranch_scc1 L_fin_done
    s_mov_b64 exec, 1
    v_mov_b32 v3, s4
    v_mov_b32 v4, 0
    v_mov_b32 v6, s94
    buffer_store_dword v3, v4, s[44:47], 0 offen sc1
    buffer_store_dword v6, v4, s[44:47], s95 offen sc1
L_fin_done:
    s_mov_b64 exec, -1
    s_endpgm
L_o_slow:
    buffer_store_dwordx4 v[48:51], v5, s[44:47], s63 offen sc1
    s_branch L_o_done
L_helper2:
    s_cmp_lg_u32 s3, 3
    s_cbranch_scc1 L_nogate
    s_mov_b32 s48, s36
    s_mov_b32 s49, s37
    s_mov_b32 s50, 0x400
    s_mov_b32 s51, 0x00020000
    s_lshr_b32 s60, s11, 5
    s_lshl_b32 s62, s60, 10
    buffer_load_dwordx4 v[32:35], v5, s[52:55], s62 offen
    buffer_load_dwordx4 v[36:39], v5, s[48:51], 0 offen
    v_mov_b32 v40, 0
    v_mov_b32 v2, 0x26480
    s_waitcnt vmcnt(0)
    v_dot2_f32_bf16 v40, v32, v36, v40
    v_dot2_f32_bf16 v40, v33, v37, v40
    v_dot2_f32_bf16 v40, v34, v38, v40
    v_dot2_f32_bf16 v40, v35, v39, v40
    s_nop 2
    v_add_f32_dpp v40, v40, v40 quad_perm:[1,0,3,2] row_mask:0xf bank_mask:0xf
    s_nop 1
    v_add_f32_dpp v40, v40, v40 quad_perm:[2,3,0,1] row_mask:0xf bank_mask:0xf
    s_nop 1
    v_add_f32_dpp v40, v40, v40 row_ror:4 row_mask:0xf bank_mask:0xf
    s_nop 1
    v_add_f32_dpp v40, v40, v40 row_ror:8 row_mask:0xf bank_mask:0xf
    v_mov_b32 v41, v40
    s_nop 1
    v_permlane16_swap_b32 v40, v41
    v_add_f32 v40, v40, v41
    v_mov_b32 v41, v40
    s_nop 1
    v_permlane32_swap_b32 v40, v41
    v_add_f32 v40, v40, v41
    v_mul_f32 v40, 0xbfb8aa3b, v40
    v_exp_f32 v40, v40
    s_nop 0
    v_add_f32 v40, 1.0, v40
    v_rcp_f32 v40, v40
    s_mov_b64 exec, 1
    ds_write_b32 v2, v40
    s_waitcnt lgkmcnt(0)
    ds_add_u32 v10, v20 offset:8
    s_and_b32 s6, s11, 31
    s_cmp_lg_u32 s6, 0
    s_cbranch_scc1 L_gate_done
    v_sub_f32 v42, 1.0, v40
    v_mov_b32 v43, s5
    v_mov_b32 v44, 0
    s_lshl_b32 s6, s60, 3
    s_add_u32 s6, s6, 0x3000
    buffer_store_dwordx2 v[42:43], v44, s[44:47], s6 offen sc1
L_gate_done:
    s_mov_b64 exec, -1
L_nogate:
    s_and_b32 s62, s11, 0xfc
    s_add_u32 s62, s62, s3
    s_mul_i32 s62, s62, 2048
    s_add_u32 s62, s62, 0x100000
    s_lshl_b32 s6, s3, 8
    s_add_u32 s6, s6, 0x26000
    v_and_b32 v2, 31, v0
    v_lshl_add_u32 v2, v2, 3, s6
    s_mov_b32 s65, 1600000
L_qt:
    ds_read_b32 v21, v10 offset:16
    s_waitcnt lgkmcnt(0)
    v_cmp_gt_u32 vcc, 1, v21
    s_nop 0
    s_cbranch_vccz L_qt_go
    s_sleep 4
    s_sub_u32 s65, s65, 1
    s_cbranch_scc0 L_qt
L_qt_go:
    s_mov_b32 s65, 400000
    s_mov_b32 s93, 5
L_qp:
    buffer_load_dwordx4 v[32:35], v5, s[44:47], s62 offen sc1
    buffer_load_dwordx4 v[36:39], v5, s[44:47], s62 offen offset:1024 sc1
    s_waitcnt vmcnt(0)
    v_xor_b32 v33, s91, v33
    v_xor_b32 v35, s91, v35
    v_xor_b32 v37, s91, v37
    v_xor_b32 v39, s91, v39
    v_or3_b32 v33, v33, v35, v37
    v_or_b32 v33, v33, v39
    v_cmp_lt_u32 vcc, 7, v33
    s_nop 0
    s_cbranch_vccz L_qp_go
    s_sleep 4
    s_sub_u32 s93, s93, 1
    s_cbranch_scc0 L_qp
    s_mov_b32 s93, 0
    s_cmp_lg_u32 s92, 0
    s_cbranch_scc1 L_rp1
    s_mov_b32 s92, 1
    s_mov_b32 exec_hi, s9
    buffer_store_dwordx4 v[112:115], v116, s[44:47], 0 offen sc1
    s_mov_b64 exec, 1
    ds_write_b32 v10, v20 offset:24
    s_mov_b64 exec, -1
L_rp1:
    s_sub_u32 s65, s65, 1
    s_cbranch_scc0 L_qp
L_qp_go:
    v_cmp_ne_u32 vcc, 0, v33
    s_nop 0
    s_cbranch_vccz L_rp2
    s_cmp_lg_u32 s92, 0
    s_cbranch_scc1 L_rp2
    s_mov_b32 s92, 1
    s_mov_b32 exec_hi, s9
    buffer_store_dwordx4 v[112:115], v116, s[44:47], 0 offen sc1
    s_mov_b64 exec, 1
    ds_write_b32 v10, v20 offset:24
    s_mov_b64 exec, -1
L_rp2:
    v_lshlrev_b32 v12, 16, v32
    v_and_b32 v13, 0xffff0000, v32
    v_lshlrev_b32 v14, 16, v34
    v_and_b32 v15, 0xffff0000, v34
    v_lshlrev_b32 v37, 16, v36
    v_and_b32 v36, 0xffff0000, v36
    v_add_f32 v12, v12, v37
    v_add_f32 v13, v13, v36
    v_lshlrev_b32 v39, 16, v38
    v_and_b32 v38, 0xffff0000, v38
    v_add_f32 v14, v14, v39
    v_add_f32 v15, v15, v38
    v_mov_b32 v16, v12
    v_mov_b32 v17, v13
    v_mov_b32 v18, v14
    v_mov_b32 v19, v15
    v_permlane32_swap_b32 v12, v16
    v_permlane32_swap_b32 v13, v17
    v_permlane32_swap_b32 v14, v18
    v_permlane32_swap_b32 v15, v19
    v_add_f32 v12, v12, v16
    v_add_f32 v13, v13, v17
    v_add_f32 v14, v14, v18
    v_add_f32 v15, v15, v19
    v_cvt_pk_bf16_f32 v12, v12, v13
    v_cvt_pk_bf16_f32 v13, v14, v15
    ds_write_b64 v2, v[12:13]
    s_waitcnt lgkmcnt(0)
    s_mov_b64 exec, 1
    ds_add_u32 v10, v20 offset:4
    s_mov_b64 exec, -1
    s_setprio 0
    s_mov_b32 s65, 1600000
L_qa:
    ds_read_b32 v21, v10 offset:4
    ds_read_b32 v22, v10 offset:24
    s_waitcnt lgkmcnt(0)
    v_cmp_ne_u32 vcc, 0, v22
    s_nop 0
    s_cbranch_vccz L_rp3
    s_cmp_lg_u32 s92, 0
    s_cbranch_scc1 L_rp3
    s_mov_b32 s92, 1
    s_mov_b32 exec_hi, s9
    buffer_store_dwordx4 v[112:115], v116, s[44:47], 0 offen sc1
    s_mov_b64 exec, 1
    ds_write_b32 v10, v20 offset:24
    s_mov_b64 exec, -1
L_rp3:
    v_cmp_gt_u32 vcc, 4, v21
    s_nop 0
    s_cbranch_vccz L_qa_go
    s_sleep 2
    s_sub_u32 s65, s65, 1
    s_cbranch_scc0 L_qa
L_qa_go:
    s_lshr_b32 s60, s2, 5
    s_and_b32 s61, s2, 7
    s_lshl_b32 s61, s61, 2
    s_bfe_u32 s6, s2, 0x20003
    s_add_u32 s61, s61, s6
    s_mov_b32 s48, s24
    s_mov_b32 s49, s25
    s_mov_b32 s50, 0x400000
    s_mov_b32 s51, 0x00020000
    s_mov_b32 s56, s32
    s_mov_b32 s57, s33
    s_mov_b32 s58, 0x1c0000
    s_mov_b32 s59, 0x00020000
    s_mov_b32 s52, s30
    s_mov_b32 s53, s31
    s_mov_b32 s54, 0xe00
    s_mov_b32 s55, 0x00020000
    s_lshl_b32 s64, s60, 7
    s_lshl_b32 s62, s61, 17
    s_add_u32 s62, s62, s64
    s_lshl_b32 s6, s3, 15
    s_add_u32 s62, s62, s6
    s_lshl_b32 s66, s61, 16
    s_add_u32 s66, s66, s64
    s_lshl_b32 s6, s3, 14
    s_add_u32 s66, s66, s6
    s_mov_b32 s90, 0x20000
    v_lshrrev_b32 v24, 3, v0
    v_and_b32 v12, 2, v24
    v_xor_b32 v12, v12, v8
    v_lshlrev_b32 v24, 10, v24
    v_lshl_add_u32 v24, v12, 4, v24
    v_xor_b32 v25, 64, v24
    v_add_u32 v26, 14336, v24
    v_add_u32 v27, 21504, v25
    v_add_u32 v25, 7168, v25
    v_bfe_u32 v12, v0, 3, 2
    v_lshlrev_b32 v12, 5, v12
    v_add3_u32 v120, v11, v12, s90
    v_xor_b32 v121, 32, v120
    v_xor_b32 v122, 64, v120
    v_xor_b32 v123, 96, v120
    v_bfe_u32 v12, v7, 2, 1
    v_mul_u32_u24 v4, 144, v12
    v_lshl_add_u32 v4, v6, 4, v4
    s_mul_i32 s6, s3, 288
    s_add_u32 s6, s6, 0x26500
    v_add_u32 v4, s6, v4
    v_bfe_u32 v12, v0, 3, 2
    v_lshlrev_b32 v53, 3, v12
    v_mul_u32_u24 v1, 144, v8
    s_lshl_b32 s6, s3, 5
    s_add_u32 s6, s6, 0x26500
    v_add3_u32 v1, v1, v53, s6
    v_lshlrev_b32 v52, 3, v8
    v_and_b32 v12, 1, v6
    v_lshlrev_b32 v11, 10, v12
    s_lshl_b32 s69, s3, 11
    s_lshl_b32 s6, s61, 5
    s_add_u32 s69, s69, s6
    s_add_u32 s69, s69, 0x10000
    s_lshl_b32 s70, s61, 14
    s_lshl_b32 s6, s3, 12
    s_add_u32 s70, s70, s6
    s_mul_i32 s63, s61, 16384
    s_add_u32 s63, s63, s6
    s_add_u32 s63, s63, 0x80000
    s_add_u32 s70, s70, 0x200000
    s_lshl_b32 s6, s3, 15
    s_add_u32 s6, s6, 0x1000
    v_lshrrev_b32 v13, 5, v0
    v_and_b32 v14, 31, v0
    v_mul_u32_u24 v13, 272, v13
    v_lshl_add_u32 v13, v14, 3, v13
    v_add_u32 v2, s6, v13
    v_mul_u32_u24 v13, 272, v8
    v_lshl_add_u32 v13, v6, 4, v13
    v_add_u32 v58, s6, v13
    v_lshlrev_b32 v59, 17, v12
    v_lshrrev_b32 v12, 3, v7
    v_lshl_add_u32 v59, v12, 12, v59
    v_lshl_add_u32 v59, v8, 4, v59
    s_lshl_b32 s71, s3, 18
    s_lshl_b32 s6, s60, 14
    s_add_u32 s71, s71, s6
    s_lshl_b32 s6, s61, 7
    s_add_u32 s71, s71, s6
    s_add_u32 s71, s71, 0x280000
    s_add_u32 s8, s71, 8192
    s_cmp_ge_u32 s61, 28
    s_cbranch_scc1 L_nohact
    s_lshl_b32 s6, s61, 7
    s_lshl_b32 s7, s3, 5
    s_add_u32 s6, s6, s7
    buffer_load_dwordx2 v[54:55], v53, s[52:55], s6 offen
    s_mov_b32 s64, 0x3000
    s_mov_b32 s65, 400000
L_hp:
    buffer_load_dwordx4 v[32:35], v5, s[44:47], s63 offen offset:0 sc1
    buffer_load_dwordx4 v[36:39], v5, s[44:47], s63 offen offset:1024 sc1
    buffer_load_dwordx4 v[40:43], v5, s[44:47], s63 offen offset:2048 sc1
    buffer_load_dwordx4 v[44:47], v5, s[44:47], s63 offen offset:3072 sc1
    buffer_load_dwordx2 v[56:57], v52, s[44:47], s64 offen sc1
    s_waitcnt vmcnt(0)
    v_xor_b32 v33, s5, v33
    v_xor_b32 v35, s5, v35
    v_xor_b32 v37, s5, v37
    v_xor_b32 v39, s5, v39
    v_xor_b32 v41, s5, v41
    v_xor_b32 v43, s5, v43
    v_xor_b32 v45, s5, v45
    v_xor_b32 v47, s5, v47
    v_xor_b32 v48, s5, v57
    v_or3_b32 v33, v33, v35, v37
    v_or3_b32 v39, v39, v41, v43
    v_or3_b32 v45, v45, v47, v48
    v_or3_b32 v33, v33, v39, v45
    v_cmp_lt_u32 vcc, 7, v33
    s_nop 0
    s_cbranch_vccz L_hp_go
    s_sleep 16
    s_sub_u32 s65, s65, 1
    s_cbranch_scc0 L_hp
L_hp_go:
    v_lshlrev_b32 v12, 16, v32
    v_and_b32 v13, 0xffff0000, v32
    v_lshlrev_b32 v14, 16, v34
    v_and_b32 v15, 0xffff0000, v34
    v_lshlrev_b32 v37, 16, v36
    v_and_b32 v36, 0xffff0000, v36
    v_add_f32 v12, v12, v37
    v_add_f32 v13, v13, v36
    v_lshlrev_b32 v39, 16, v38
    v_and_b32 v38, 0xffff0000, v38
    v_add_f32 v14, v14, v39
    v_add_f32 v15, v15, v38
    v_lshlrev_b32 v41, 16, v40
    v_and_b32 v40, 0xffff0000, v40
    v_add_f32 v12, v12, v41
    v_add_f32 v13, v13, v40
    v_lshlrev_b32 v43, 16, v42
    v_and_b32 v42, 0xffff0000, v42
    v_add_f32 v14, v14, v43
    v_add_f32 v15, v15, v42
    v_lshlrev_b32 v45, 16, v44
    v_and_b32 v44, 0xffff0000, v44
    v_add_f32 v12, v12, v45
    v_add_f32 v13, v13, v44
    v_lshlrev_b32 v47, 16, v46
    v_and_b32 v46, 0xffff0000, v46
    v_add_f32 v14, v14, v47
    v_add_f32 v15, v15, v46
    v_mov_b32 v16, v12
    v_mov_b32 v17, v13
    v_mov_b32 v18, v14
    v_mov_b32 v19, v15
    v_permlane32_swap_b32 v12, v16
    v_permlane32_swap_b32 v13, v17
    v_permlane32_swap_b32 v14, v18
    v_permlane32_swap_b32 v15, v19
    v_add_f32 v12, v12, v16
    v_add_f32 v13, v13, v17
    v_add_f32 v14, v14, v18
    v_add_f32 v15, v15, v19
    v_lshlrev_b32 v16, 16, v54
    v_and_b32 v17, 0xffff0000, v54
    v_lshlrev_b32 v18, 16, v55
    v_and_b32 v19, 0xffff0000, v55
    v_add_f32 v12, v12, v16
    v_add_f32 v13, v13, v17
    v_add_f32 v14, v14, v18
    v_add_f32 v15, v15, v19
    v_max_f32 v12, 0, v12
    v_max_f32 v13, 0, v13
    v_max_f32 v14, 0, v14
    v_max_f32 v15, 0, v15
    v_mul_f32 v16, v12, v56
    v_mul_f32 v17, v13, v56
    v_mul_f32 v18, v14, v56
    v_mul_f32 v19, v15, v56
    v_mul_f32 v12, v12, v16
    v_mul_f32 v13, v13, v17
    v_mul_f32 v14, v14, v18
    v_mul_f32 v15, v15, v19
    v_cvt_pk_bf16_f32 v12, v12, v13
    v_cvt_pk_bf16_f32 v13, v14, v15
    ds_write_b64 v1, v[12:13]
L_nohact:
    s_cmp_lg_u32 s3, 0
    s_cbranch_scc1 L_nolse
    s_mov_b32 s65, 1600000
L_hml:
    ds_read_b32 v21, v10 offset:8
    s_waitcnt lgkmcnt(0)
    v_cmp_gt_u32 vcc, 5, v21
    s_nop 0
    s_cbranch_vccz L_hml_go
    s_sleep 8
    s_sub_u32 s65, s65, 1
    s_cbranch_scc0 L_hml
L_hml_go:
    v_lshlrev_b32 v12, 4, v9
    v_add_u32 v12, 0x26400, v12
    ds_read_b128 v[16:19], v12
    ds_read_b128 v[32:35], v12 offset:64
    s_and_b32 s6, s11, 0xfc
    s_lshl_b32 s6, s6, 5
    s_and_b32 s7, s11, 3
    s_lshl_b32 s7, s7, 3
    s_add_u32 s6, s6, s7
    s_add_u32 s6, s6, 0x10000
    v_lshlrev_b32 v13, 5, v9
    s_waitcnt lgkmcnt(0)
    v_max3_f32 v14, v16, v17, v18
    v_max_f32 v14, v14, v19
    v_sub_f32 v16, v16, v14
    v_sub_f32 v17, v17, v14
    v_sub_f32 v18, v18, v14
    v_sub_f32 v19, v19, v14
    v_exp_f32 v16, v16
    v_exp_f32 v17, v17
    v_exp_f32 v18, v18
    v_exp_f32 v19, v19
    v_mul_f32 v36, v16, v32
    v_fma_f32 v36, v17, v33, v36
    v_fma_f32 v36, v18, v34, v36
    v_fma_f32 v36, v19, v35, v36
    v_log_f32 v36, v36
    v_mov_b32 v15, s5
    v_add_f32 v14, v14, v36
    s_mov_b64 exec, 15
    s_cmp_lg_u32 s92, 0
    s_cbranch_scc1 L_lse_slow
    buffer_store_dwordx2 v[14:15], v13, s[44:47], s6 offen
    s_branch L_lse_done
L_lse_slow:
    buffer_store_dwordx2 v[14:15], v13, s[44:47], s6 offen sc1
L_lse_done:
    s_mov_b64 exec, -1
    s_sub_u32 s6, s6, s7
    s_mov_b32 s65, 400000
L_lp:
    s_sleep 8
    buffer_load_dwordx4 v[28:31], v13, s[44:47], s6 offen sc1
    buffer_load_dwordx4 v[32:35], v13, s[44:47], s6 offen offset:16 sc1
    s_waitcnt vmcnt(0)
    v_xor_b32 v29, s5, v29
    v_xor_b32 v31, s5, v31
    v_xor_b32 v33, s5, v33
    v_xor_b32 v35, s5, v35
    v_or3_b32 v29, v29, v31, v33
    v_or_b32 v29, v29, v35
    v_cmp_ne_u32 vcc, 0, v29
    s_sub_u32 s65, s65, 1
    s_cbranch_scc1 L_lp_go
    s_cbranch_vccnz L_lp
L_lp_go:
    v_max3_f32 v44, v28, v30, v32
    v_max_f32 v44, v44, v34
    v_sub_f32 v48, v28, v44
    v_sub_f32 v49, v30, v44
    v_sub_f32 v50, v32, v44
    v_sub_f32 v51, v34, v44
    v_exp_f32 v48, v48
    v_exp_f32 v49, v49
    v_exp_f32 v50, v50
    v_exp_f32 v51, v51
    v_add_f32 v48, v48, v49
    v_add_f32 v50, v50, v51
    v_add_f32 v48, v48, v50
    v_log_f32 v48, v48
    v_lshlrev_b32 v12, 2, v9
    v_add_u32 v12, 0x26490, v12
    v_add_f32 v48, v48, v44
    s_mov_b64 exec, 15
    ds_write_b32 v12, v48
    s_mov_b64 exec, 1
    ds_add_u32 v10, v20 offset:8
    s_mov_b64 exec, -1
L_nolse:
    s_mov_b32 s65, 1600000
L_trig:
    ds_read_b32 v21, v10 offset:12
    s_waitcnt lgkmcnt(0)
    v_cmp_gt_u32 vcc, 4, v21
    s_nop 0
    s_cbranch_vccz L_trig_go
    s_sleep 2
    s_sub_u32 s65, s65, 1
    s_cbranch_scc0 L_trig
L_trig_go:
    s_setprio 1
    s_mov_b32 m0, s67
    s_nop 0
    buffer_load_dwordx4 v24, s[48:51], s62 offen offset:0 nt lds
    buffer_load_dwordx4 v25, s[48:51], s62 offen offset:1024 nt lds
    buffer_load_dwordx4 v26, s[48:51], s62 offen offset:2048 nt lds
    buffer_load_dwordx4 v27, s[48:51], s62 offen offset:3072 nt lds
    s_mov_b32 m0, s68
    s_nop 0
    buffer_load_dwordx4 v24, s[56:59], s66 offen offset:0 nt lds
    buffer_load_dwordx4 v25, s[56:59], s66 offen offset:1024 nt lds
    v_mov_b32 v65, s5
    v_mov_b32 v67, s5
    v_mov_b32 v69, s5
    v_mov_b32 v71, s5
    v_add_u32 v9, 1088, v2
    v_mov_b32 v36, 1
    v_mov_b32 v60, 0
    v_mov_b32 v61, 0
    v_mov_b32 v62, 0
    v_mov_b32 v63, 0
    s_waitcnt vmcnt(0)
    s_mov_b64 exec, 1
    ds_add_u32 v10, v36 offset:0
    s_mov_b64 exec, -1
    s_mov_b32 s65, 1600000
L_s2:
    ds_read_b32 v37, v10 offset:0
    s_waitcnt lgkmcnt(0)
    v_cmp_gt_u32 vcc, 8, v37
    s_nop 0
    s_cbranch_vccz L_s2_go
    s_sleep 1
    s_sub_u32 s65, s65, 1
    s_cbranch_scc0 L_s2
L_s2_go:
    buffer_load_dwordx4 v[12:15], v5, s[44:47], s70 offen offset:0 sc1
    buffer_load_dwordx4 v[16:19], v5, s[44:47], s70 offen offset:1024 sc1
    buffer_load_dwordx4 v[20:23], v5, s[44:47], s70 offen offset:2048 sc1
    buffer_load_dwordx4 v[24:27], v5, s[44:47], s70 offen offset:3072 sc1
    ds_read_b64_tr_b16 v[128:129], v120 offset:0
    ds_read_b64_tr_b16 v[130:131], v120 offset:512
    ds_read_b64_tr_b16 v[132:133], v121 offset:0
    ds_read_b64_tr_b16 v[134:135], v121 offset:512
    ds_read_b64_tr_b16 v[136:137], v122 offset:0
    ds_read_b64_tr_b16 v[138:139], v122 offset:512
    ds_read_b64_tr_b16 v[140:141], v123 offset:0
    ds_read_b64_tr_b16 v[142:143], v123 offset:512
    s_waitcnt lgkmcnt(6)
    ds_read_b64_tr_b16 v[144:145], v120 offset:4096
    ds_read_b64_tr_b16 v[146:147], v120 offset:4608
    ds_read_b64_tr_b16 v[148:149], v121 offset:4096
    ds_read_b64_tr_b16 v[150:151], v121 offset:4608
    ds_read_b64_tr_b16 v[152:153], v122 offset:4096
    ds_read_b64_tr_b16 v[154:155], v122 offset:4608
    ds_read_b64_tr_b16 v[156:157], v123 offset:4096
    ds_read_b64_tr_b16 v[158:159], v123 offset:4608
    s_waitcnt lgkmcnt(6)
    ds_read_b64_tr_b16 v[160:161], v120 offset:8192
    ds_read_b64_tr_b16 v[162:163], v120 offset:8704
    ds_read_b64_tr_b16 v[164:165], v121 offset:8192
    ds_read_b64_tr_b16 v[166:167], v121 offset:8704
    ds_read_b64_tr_b16 v[168:169], v122 offset:8192
    ds_read_b64_tr_b16 v[170:171], v122 offset:8704
    ds_read_b64_tr_b16 v[172:173], v123 offset:8192
    ds_read_b64_tr_b16 v[174:175], v123 offset:8704
    s_waitcnt lgkmcnt(6)
    ds_read_b64_tr_b16 v[176:177], v120 offset:12288
    ds_read_b64_tr_b16 v[178:179], v120 offset:12800
    ds_read_b64_tr_b16 v[180:181], v121 offset:12288
    ds_read_b64_tr_b16 v[182:183], v121 offset:12800
    ds_read_b64_tr_b16 v[184:185], v122 offset:12288
    ds_read_b64_tr_b16 v[186:187], v122 offset:12800
    ds_read_b64_tr_b16 v[188:189], v123 offset:12288
    ds_read_b64_tr_b16 v[190:191], v123 offset:12800
    s_waitcnt lgkmcnt(6)
    s_cmp_ge_u32 s61, 28
    s_cbranch_scc1 L_nomlp
    ds_read_b64_tr_b16 v[192:193], v120 offset:16384
    ds_read_b64_tr_b16 v[194:195], v120 offset:16896
    ds_read_b64_tr_b16 v[196:197], v121 offset:16384
    ds_read_b64_tr_b16 v[198:199], v121 offset:16896
    ds_read_b64_tr_b16 v[200:201], v122 offset:16384
    ds_read_b64_tr_b16 v[202:203], v122 offset:16896
    ds_read_b64_tr_b16 v[204:205], v123 offset:16384
    ds_read_b64_tr_b16 v[206:207], v123 offset:16896
    s_waitcnt lgkmcnt(4)
    ds_read_b64_tr_b16 v[208:209], v120 offset:20480
    ds_read_b64_tr_b16 v[210:211], v120 offset:20992
    ds_read_b64_tr_b16 v[212:213], v121 offset:20480
    ds_read_b64_tr_b16 v[214:215], v121 offset:20992
    ds_read_b64_tr_b16 v[216:217], v122 offset:20480
    ds_read_b64_tr_b16 v[218:219], v122 offset:20992
    ds_read_b64_tr_b16 v[220:221], v123 offset:20480
    ds_read_b64_tr_b16 v[222:223], v123 offset:20992
    s_waitcnt lgkmcnt(4)
    ds_read_b128 v[88:91], v4
    ds_read_b128 v[92:95], v4 offset:64
    s_waitcnt lgkmcnt(0)
    v_mfma_f32_16x16x32_bf16 v[96:99], v[88:91], v[192:195], 0
    v_mfma_f32_16x16x32_bf16 v[100:103], v[88:91], v[196:199], 0
    v_mfma_f32_16x16x32_bf16 v[104:107], v[88:91], v[200:203], 0
    v_mfma_f32_16x16x32_bf16 v[108:111], v[88:91], v[204:207], 0
    v_mfma_f32_16x16x32_bf16 v[96:99], v[92:95], v[208:211], v[96:99]
    v_mfma_f32_16x16x32_bf16 v[100:103], v[92:95], v[212:215], v[100:103]
    v_mfma_f32_16x16x32_bf16 v[104:107], v[92:95], v[216:219], v[104:107]
    v_mfma_f32_16x16x32_bf16 v[108:111], v[92:95], v[220:223], v[108:111]
    s_nop 4
    v_mov_b32 v60, v96
    v_mov_b32 v61, v100
    v_mov_b32 v62, v104
    v_mov_b32 v63, v108
L_nomlp:
    s_mov_b32 s64, 400000
    s_branch L_p2_body
L_p2_poll:
    s_sleep 2
    buffer_load_dwordx4 v[12:15], v5, s[44:47], s70 offen offset:0 sc1
    buffer_load_dwordx4 v[16:19], v5, s[44:47], s70 offen offset:1024 sc1
    buffer_load_dwordx4 v[20:23], v5, s[44:47], s70 offen offset:2048 sc1
    buffer_load_dwordx4 v[24:27], v5, s[44:47], s70 offen offset:3072 sc1
L_p2_body:
    s_waitcnt vmcnt(3)
    ds_write2_b32 v2, v12, v14 offset0:0 offset1:1
    v_xor_b32 v28, s5, v13
    v_xor_b32 v29, s5, v15
    s_waitcnt vmcnt(2)
    ds_write2_b32 v2, v16, v18 offset0:136 offset1:137
    v_xor_b32 v30, s5, v17
    v_xor_b32 v31, s5, v19
    s_waitcnt vmcnt(1)
    ds_write2_b32 v9, v20, v22 offset0:0 offset1:1
    v_xor_b32 v32, s5, v21
    v_xor_b32 v33, s5, v23
    s_waitcnt vmcnt(0)
    ds_write2_b32 v9, v24, v26 offset0:136 offset1:137
    v_xor_b32 v34, s5, v25
    v_xor_b32 v35, s5, v27
    v_or3_b32 v28, v28, v29, v30
    v_or3_b32 v31, v31, v32, v33
    v_or3_b32 v28, v28, v34, v35
    v_or_b32 v28, v28, v31
    v_cmp_ne_u32 vcc, 0, v28
    s_sub_u32 s64, s64, 1
    s_waitcnt lgkmcnt(0)
    s_cbranch_scc1 L_p2_go
    s_cbranch_vccnz L_p2_poll
L_p2_go:
    ds_read_b128 v[72:75], v58 offset:0
    ds_read_b128 v[76:79], v58 offset:64
    ds_read_b128 v[80:83], v58 offset:128
    ds_read_b128 v[84:87], v58 offset:192
    s_waitcnt lgkmcnt(3)
    v_mfma_f32_16x16x32_bf16 v[96:99], v[72:75], v[128:131], 0
    v_mfma_f32_16x16x32_bf16 v[100:103], v[72:75], v[132:135], 0
    v_mfma_f32_16x16x32_bf16 v[104:107], v[72:75], v[136:139], 0
    v_mfma_f32_16x16x32_bf16 v[108:111], v[72:75], v[140:143], 0
    s_waitcnt lgkmcnt(2)
    v_mfma_f32_16x16x32_bf16 v[96:99], v[76:79], v[144:147], v[96:99]
    v_mfma_f32_16x16x32_bf16 v[100:103], v[76:79], v[148:151], v[100:103]
    v_mfma_f32_16x16x32_bf16 v[104:107], v[76:79], v[152:155], v[104:107]
    v_mfma_f32_16x16x32_bf16 v[108:111], v[76:79], v[156:159], v[108:111]
    s_waitcnt lgkmcnt(1)
    v_mfma_f32_16x16x32_bf16 v[96:99], v[80:83], v[160:163], v[96:99]
    v_mfma_f32_16x16x32_bf16 v[100:103], v[80:83], v[164:167], v[100:103]
    v_mfma_f32_16x16x32_bf16 v[104:107], v[80:83], v[168:171], v[104:107]
    v_mfma_f32_16x16x32_bf16 v[108:111], v[80:83], v[172:175], v[108:111]
    s_waitcnt lgkmcnt(0)
    v_mfma_f32_16x16x32_bf16 v[96:99], v[84:87], v[176:179], v[96:99]
    v_mfma_f32_16x16x32_bf16 v[100:103], v[84:87], v[180:183], v[100:103]
    v_mfma_f32_16x16x32_bf16 v[104:107], v[84:87], v[184:187], v[104:107]
    v_mfma_f32_16x16x32_bf16 v[108:111], v[84:87], v[188:191], v[108:111]
    s_mov_b64 exec, 0xffffffff
    s_nop 3
    v_add_f32 v60, v60, v96
    v_add_f32 v48, v97, v98
    v_add_f32 v60, v60, v99
    v_add_f32 v64, v60, v48
    v_add_f32 v61, v61, v100
    v_add_f32 v49, v101, v102
    v_add_f32 v61, v61, v103
    v_add_f32 v66, v61, v49
    buffer_store_dwordx4 v[64:67], v59, s[44:47], s71 offen sc1
    v_add_f32 v62, v62, v104
    v_add_f32 v50, v105, v106
    v_add_f32 v62, v62, v107
    v_add_f32 v68, v62, v50
    v_add_f32 v63, v63, v108
    v_add_f32 v51, v109, v110
    v_add_f32 v63, v63, v111
    v_add_f32 v70, v63, v51
    buffer_store_dwordx4 v[68:71], v59, s[44:47], s8 offen sc1
    s_mov_b64 exec, -1
L_end:
    s_endpgm
.section .rodata,"a"
.p2align 6
.amdhsa_kernel gated_mix__gqa_block_cached__dense_activation_squared_relu__decode_kernel
  .amdhsa_next_free_vgpr 256
  .amdhsa_next_free_sgpr 96
  .amdhsa_accum_offset 256
  .amdhsa_group_segment_fixed_size 0
  .amdhsa_kernarg_size 112
  .amdhsa_user_sgpr_count 2
  .amdhsa_user_sgpr_kernarg_segment_ptr 1
  .amdhsa_system_sgpr_workgroup_id_x 1
.end_amdhsa_kernel
```
